```python
import torch

def _softmax(x, axis=-1):
    return torch.softmax(x, dim=axis)
def _gelu(x):
    return torch.nn.functional.gelu(x, approximate="tanh")
def _silu(x):
    return torch.nn.functional.silu(x)
def _sigmoid(x):
    return torch.sigmoid(x)
def _layernorm(x, axis=-1, eps=1e-5):
    m = x.mean(dim=axis, keepdim=True)
    v = x.var(dim=axis, keepdim=True, unbiased=False)
    return (x - m) / torch.sqrt(v + eps)
def _scatter_add(tgt, idx, src, axis=0):
    return tgt.clone().index_add_(axis, idx, src)
def _segment_sum(src, seg, n):
    out = torch.zeros((n,) + src.shape[1:], dtype=src.dtype)
    return out.index_add_(0, seg, src)
def _pad(x, pw):
    flat = tuple(v for pair in reversed(pw) for v in pair)
    return torch.nn.functional.pad(x, flat)

kernel_name = 'parallel_sum__sliding_block_cached__mixer_channel_mlp__decode'

def setup_inputs():

    _w = (lambda a: (lambda t: t.to(torch.bfloat16) if t.is_floating_point() else t)(torch.as_tensor(a)))
    def _A_setup():
        B, Sq, D = 1, 1, 576
        Hq, Hkv, Sk, Dh = 32, 16, 65536, 128
        assert Hq % Hkv == 0, (Hq, Hkv)
        return {
            "x": _w((lambda *s: torch.randn(*s, dtype=torch.bfloat16) * 0.05)(B, Sq, D)),
            "k_cache": _w((lambda *s: torch.randn(*s, dtype=torch.bfloat16) * 3.2)(B, Hkv, Sk, Dh)),
            "v_cache": _w((lambda *s: torch.randn(*s, dtype=torch.bfloat16) * 0.4)(B, Hkv, Sk, Dh)),
            "wq": _w((lambda *s: torch.randn(*s, dtype=torch.bfloat16) * 3.2)(D, Hq * Dh) * (D ** -0.5)),
            "wo": _w((lambda *s: torch.randn(*s, dtype=torch.bfloat16) * 0.4)(Hq * Dh, D) * ((Hq * Dh) ** -0.5)),
        }
    _A_in = _A_setup()

    def _B_setup():
        B, S, D, F = 1, 1, 576, 4608
        return {
            "x": _w((lambda *s: torch.randn(*s, dtype=torch.bfloat16) * 0.05)(B, S, D)),
            "w1": _w((lambda *s: torch.randn(*s, dtype=torch.bfloat16) * 3.2)(D, F) * (D ** -0.5)),
            "b1": _w((lambda *s: torch.randn(*s, dtype=torch.bfloat16) * 0.8)(F)),
            "w2": _w((lambda *s: torch.randn(*s, dtype=torch.bfloat16) * 0.1)(F, D) * (F ** -0.5)),
            "b2": _w((lambda *s: torch.randn(*s, dtype=torch.bfloat16) * 0.1)(D)),
        }
    _B_in = _B_setup()

    return {
        "A_x": _A_in["x"],
        "A_k_cache": _A_in["k_cache"],
        "A_v_cache": _A_in["v_cache"],
        "A_wq": _A_in["wq"],
        "A_wo": _A_in["wo"],
        "B_x": _B_in["x"],
        "B_w1": _B_in["w1"],
        "B_b1": _B_in["b1"],
        "B_w2": _B_in["w2"],
        "B_b2": _B_in["b2"],
    }

def reference(A_x, A_k_cache, A_v_cache, A_wq, A_wo, B_x, B_w1, B_b1, B_w2, B_b2):
    def _A_ref(x, k_cache, v_cache, wq, wo):
        B, Sq, D = x.shape
        Hq, Dh = 32, 128
        Hkv, Sk = k_cache.shape[1], k_cache.shape[2]
        W = min(4096, max(256, Sk // 4))
        rep = Hq // Hkv
        q = (lambda x, *d: x.permute(*d))((x @ wq).reshape(B, Sq, Hq, Dh), 0, 2, 1, 3)
        k = (lambda x, n, axis: torch.repeat_interleave(x, n, dim=axis))(k_cache[:, :, Sk - W:, :], rep, axis=1)
        v = (lambda x, n, axis: torch.repeat_interleave(x, n, dim=axis))(v_cache[:, :, Sk - W:, :], rep, axis=1)
        scores = torch.einsum("bhqd,bhkd->bhqk", q, k) * (Dh ** -0.5)
        p = _softmax(scores, axis=-1)
        o = torch.einsum("bhqk,bhkd->bhqd", p, v)
        return (lambda x, *d: x.permute(*d))(o, 0, 2, 1, 3).reshape(B, Sq, Hq * Dh) @ wo

    def _B_ref(x, w1, b1, w2, b2):
        y = _layernorm(x, axis=-1)
        h = _gelu(torch.einsum("bsd,df->bsf", y, w1) + b1)
        return torch.einsum("bsf,fd->bsd", h, w2) + b2

    x = A_x
    xn = _layernorm(x, axis=-1)
    return x + _A_ref(xn, A_k_cache, A_v_cache, A_wq, A_wo) + _B_ref(xn, B_w1, B_b1, B_w2, B_b2)
```

```asm
; @launch grid=(256,1,1) block=(1024,1,1) lds=100352
.amdgcn_target "amdgcn-amd-amdhsa--gfx950"
.text
.globl parallel_sum__sliding_block_cached__mixer_channel_mlp__decode_kernel
.p2align 8
.type parallel_sum__sliding_block_cached__mixer_channel_mlp__decode_kernel,@function
parallel_sum__sliding_block_cached__mixer_channel_mlp__decode_kernel:
    s_cmp_ge_u32 s2, 256
    s_cbranch_scc1 L_end
    s_load_dwordx16 s[16:31], s[0:1], 0
    s_load_dwordx8 s[32:39], s[0:1], 64
    s_load_dwordx2 s[40:41], s[0:1], 96
    v_lshrrev_b32 v1, 6, v0
    v_and_b32 v0, 63, v0
    v_readfirstlane_b32 s3, v1
    v_lshlrev_b32 v2, 4, v0
    v_mov_b32 v1, 0xffffff00
    s_lshr_b32 s4, s2, 4
    s_and_b32 s5, s2, 15
    s_lshr_b32 s6, s2, 1
    s_and_b32 s7, s2, 1
    s_mul_i32 s72, s7, 640
    s_mov_b32 s70, -1
    s_cmp_eq_u32 s7, 0
    s_cselect_b32 s71, 0xff, 0
    s_waitcnt lgkmcnt(0)
    s_load_dword s42, s[40:41], 0
    s_mov_b32 s44, s40
    s_and_b32 s45, s41, 0xffff
    s_mov_b32 s46, 1073741824
    s_mov_b32 s47, 0x00020000
    s_mov_b32 s60, s24
    s_and_b32 s61, s25, 0xffff
    s_mov_b32 s62, 4718592
    s_mov_b32 s63, 0x00020000
    s_cmp_ge_u32 s3, 8
    s_cbranch_scc1 L_stream
    s_mov_b32 s48, s16
    s_and_b32 s49, s17, 0xffff
    s_mov_b32 s50, 1152
    s_mov_b32 s51, 0x00020000
    s_and_b32 s8, s3, 3
    v_lshlrev_b32 v3, 2, v0
    buffer_load_dwordx4 v[24:27], v2, s[48:51], 0 offen
    buffer_load_dword v28, v3, s[48:51], 0 offen offset:1024
    s_cmp_ge_u32 s3, 4
    s_cbranch_scc1 L_hh
    s_mov_b32 s52, s22
    s_and_b32 s53, s23, 0xffff
    s_mov_b32 s54, 4718592
    s_mov_b32 s55, 0x00020000
    s_lshr_b32 s9, s5, 2
    s_and_b32 s10, s5, 3
    s_mul_i32 s11, s9, 144
    s_mul_i32 s12, s8, 36
    s_add_u32 s73, s11, s12
    s_lshl_b32 s11, s73, 13
    s_lshl_b32 s12, s4, 9
    s_add_u32 s11, s11, s12
    s_lshl_b32 s12, s10, 7
    s_add_u32 s11, s11, s12
    v_lshrrev_b32 v4, 3, v0
    s_mov_b32 s14, 8192
    v_mul_lo_u32 v4, v4, s14
    v_and_b32 v5, 7, v0
    v_lshl_add_u32 v4, v5, 4, v4
    s_mul_i32 s12, s8, 4608
    s_add_u32 s12, s12, 57344
    s_mov_b32 m0, s12
    s_nop 0
    buffer_load_dwordx4 v4, s[52:55], s11 offen nt lds
    s_add_u32 s11, s11, 65536
    s_add_u32 s12, s12, 1024
    s_mov_b32 m0, s12
    s_nop 0
    buffer_load_dwordx4 v4, s[52:55], s11 offen nt lds
    s_add_u32 s11, s11, 65536
    s_add_u32 s12, s12, 1024
    s_mov_b32 m0, s12
    s_nop 0
    buffer_load_dwordx4 v4, s[52:55], s11 offen nt lds
    s_add_u32 s11, s11, 65536
    s_add_u32 s12, s12, 1024
    s_mov_b32 m0, s12
    s_nop 0
    buffer_load_dwordx4 v4, s[52:55], s11 offen nt lds
    s_add_u32 s11, s11, 65536
    s_add_u32 s12, s12, 1024
    s_mov_b32 exec_lo, 0xffffffff
    s_mov_b32 exec_hi, 0x0
    s_mov_b32 m0, s12
    s_nop 0
    buffer_load_dwordx4 v4, s[52:55], s11 offen nt lds
    s_add_u32 s11, s11, 65536
    s_add_u32 s12, s12, 1024
    s_mov_b64 exec, -1
    s_cmp_lg_u32 s3, 0
    s_cbranch_scc1 L_h_noinit
    v_lshlrev_b32 v3, 2, v0
    v_mov_b32 v4, 0
    ds_write_b32 v3, v4
L_h_noinit:
    s_waitcnt lgkmcnt(0)
    s_barrier
    s_add_u32 s42, s42, 1
    s_and_b32 s64, s42, 0xff
    s_bfe_u32 s65, s42, 0x80008
    s_bfe_u32 s66, s42, 0x80010
    s_lshr_b32 s67, s42, 24
    s_add_u32 s65, s65, s64
    s_add_u32 s66, s66, s64
    s_add_u32 s67, s67, s64
    s_and_b32 s65, s65, 0xff
    s_and_b32 s66, s66, 0xff
    s_and_b32 s67, s67, 0xff
    v_cmp_gt_u32 vcc, 32, v0
    v_mov_b32 v30, 0
    v_mov_b32 v31, 1.0
    s_nop 0
    v_cndmask_b32 v30, v30, v31, vcc
    s_waitcnt vmcnt(5)
    v_lshlrev_b32 v8, 16, v24
    v_and_b32 v9, 0xffff0000, v24
    v_lshlrev_b32 v10, 16, v25
    v_and_b32 v11, 0xffff0000, v25
    v_lshlrev_b32 v12, 16, v26
    v_and_b32 v13, 0xffff0000, v26
    v_lshlrev_b32 v14, 16, v27
    v_and_b32 v15, 0xffff0000, v27
    v_lshlrev_b32 v16, 16, v28
    v_and_b32 v17, 0xffff0000, v28
    v_add_f32 v4, v8, v9
    v_add_f32 v4, v4, v10
    v_add_f32 v4, v4, v11
    v_add_f32 v4, v4, v12
    v_add_f32 v4, v4, v13
    v_add_f32 v4, v4, v14
    v_add_f32 v4, v4, v15
    v_add_f32 v4, v4, v16
    v_add_f32 v4, v4, v17
    s_nop 1
    v_add_f32_dpp v4, v4, v4 row_ror:8 row_mask:0xf bank_mask:0xf
    s_nop 1
    v_add_f32_dpp v4, v4, v4 row_ror:4 row_mask:0xf bank_mask:0xf
    s_nop 1
    v_add_f32_dpp v4, v4, v4 row_ror:2 row_mask:0xf bank_mask:0xf
    s_nop 1
    v_add_f32_dpp v4, v4, v4 row_ror:1 row_mask:0xf bank_mask:0xf
    s_nop 0
    v_readlane_b32 s80, v4, 0
    v_readlane_b32 s81, v4, 16
    v_readlane_b32 s82, v4, 32
    v_readlane_b32 s83, v4, 48
    v_mov_b32 v4, s80
    v_add_f32 v4, s81, v4
    v_add_f32 v4, s82, v4
    v_add_f32 v4, s83, v4
    s_mov_b32 s10, 0x3ae38e39
    v_mul_f32 v4, s10, v4
    v_mov_b32 v5, 0
    v_sub_f32 v6, v8, v4
    v_fmac_f32 v5, v6, v6
    v_sub_f32 v6, v9, v4
    v_fmac_f32 v5, v6, v6
    v_sub_f32 v6, v10, v4
    v_fmac_f32 v5, v6, v6
    v_sub_f32 v6, v11, v4
    v_fmac_f32 v5, v6, v6
    v_sub_f32 v6, v12, v4
    v_fmac_f32 v5, v6, v6
    v_sub_f32 v6, v13, v4
    v_fmac_f32 v5, v6, v6
    v_sub_f32 v6, v14, v4
    v_fmac_f32 v5, v6, v6
    v_sub_f32 v6, v15, v4
    v_fmac_f32 v5, v6, v6
    v_sub_f32 v6, v16, v4
    v_mul_f32 v6, v6, v30
    v_fmac_f32 v5, v6, v6
    v_sub_f32 v6, v17, v4
    v_mul_f32 v6, v6, v30
    v_fmac_f32 v5, v6, v6
    s_nop 1
    v_add_f32_dpp v5, v5, v5 row_ror:8 row_mask:0xf bank_mask:0xf
    s_nop 1
    v_add_f32_dpp v5, v5, v5 row_ror:4 row_mask:0xf bank_mask:0xf
    s_nop 1
    v_add_f32_dpp v5, v5, v5 row_ror:2 row_mask:0xf bank_mask:0xf
    s_nop 1
    v_add_f32_dpp v5, v5, v5 row_ror:1 row_mask:0xf bank_mask:0xf
    s_nop 0
    v_readlane_b32 s80, v5, 0
    v_readlane_b32 s81, v5, 16
    v_readlane_b32 s82, v5, 32
    v_readlane_b32 s83, v5, 48
    v_mov_b32 v5, s80
    v_add_f32 v5, s81, v5
    v_add_f32 v5, s82, v5
    v_add_f32 v5, s83, v5
    v_mul_f32 v5, s10, v5
    v_cvt_pk_bf16_f32 v6, v4, v5
    v_lshlrev_b32 v4, 16, v6
    v_and_b32 v5, 0xffff0000, v6
    v_add_f32 v5, 0x3727c5ac, v5
    v_cvt_pk_bf16_f32 v5, v5, v5
    v_lshlrev_b32 v5, 16, v5
    v_sqrt_f32 v5, v5
    s_nop 0
    v_cvt_pk_bf16_f32 v5, v5, v5
    v_lshlrev_b32 v5, 16, v5
    v_rcp_f32 v7, v5
    s_nop 0
    v_sub_f32 v8, v8, v4
    v_sub_f32 v9, v9, v4
    v_cvt_pk_bf16_f32 v6, v8, v9
    v_lshlrev_b32 v8, 16, v6
    v_and_b32 v9, 0xffff0000, v6
    v_mul_f32 v6, v8, v7
    v_fma_f32 v8, -v6, v5, v8
    v_fma_f32 v8, v8, v7, v6
    v_mul_f32 v6, v9, v7
    v_fma_f32 v9, -v6, v5, v9
    v_fma_f32 v9, v9, v7, v6
    v_cvt_pk_bf16_f32 v6, v8, v9
    v_lshlrev_b32 v8, 16, v6
    v_and_b32 v9, 0xffff0000, v6
    v_sub_f32 v10, v10, v4
    v_sub_f32 v11, v11, v4
    v_cvt_pk_bf16_f32 v6, v10, v11
    v_lshlrev_b32 v10, 16, v6
    v_and_b32 v11, 0xffff0000, v6
    v_mul_f32 v6, v10, v7
    v_fma_f32 v10, -v6, v5, v10
    v_fma_f32 v10, v10, v7, v6
    v_mul_f32 v6, v11, v7
    v_fma_f32 v11, -v6, v5, v11
    v_fma_f32 v11, v11, v7, v6
    v_cvt_pk_bf16_f32 v6, v10, v11
    v_lshlrev_b32 v10, 16, v6
    v_and_b32 v11, 0xffff0000, v6
    v_sub_f32 v12, v12, v4
    v_sub_f32 v13, v13, v4
    v_cvt_pk_bf16_f32 v6, v12, v13
    v_lshlrev_b32 v12, 16, v6
    v_and_b32 v13, 0xffff0000, v6
    v_mul_f32 v6, v12, v7
    v_fma_f32 v12, -v6, v5, v12
    v_fma_f32 v12, v12, v7, v6
    v_mul_f32 v6, v13, v7
    v_fma_f32 v13, -v6, v5, v13
    v_fma_f32 v13, v13, v7, v6
    v_cvt_pk_bf16_f32 v6, v12, v13
    v_lshlrev_b32 v12, 16, v6
    v_and_b32 v13, 0xffff0000, v6
    v_sub_f32 v14, v14, v4
    v_sub_f32 v15, v15, v4
    v_cvt_pk_bf16_f32 v6, v14, v15
    v_lshlrev_b32 v14, 16, v6
    v_and_b32 v15, 0xffff0000, v6
    v_mul_f32 v6, v14, v7
    v_fma_f32 v14, -v6, v5, v14
    v_fma_f32 v14, v14, v7, v6
    v_mul_f32 v6, v15, v7
    v_fma_f32 v15, -v6, v5, v15
    v_fma_f32 v15, v15, v7, v6
    v_cvt_pk_bf16_f32 v6, v14, v15
    v_lshlrev_b32 v14, 16, v6
    v_and_b32 v15, 0xffff0000, v6
    v_sub_f32 v16, v16, v4
    v_sub_f32 v17, v17, v4
    v_cvt_pk_bf16_f32 v6, v16, v17
    v_lshlrev_b32 v16, 16, v6
    v_and_b32 v17, 0xffff0000, v6
    v_mul_f32 v6, v16, v7
    v_fma_f32 v16, -v6, v5, v16
    v_fma_f32 v16, v16, v7, v6
    v_mul_f32 v6, v17, v7
    v_fma_f32 v17, -v6, v5, v17
    v_fma_f32 v17, v17, v7, v6
    v_cvt_pk_bf16_f32 v6, v16, v17
    v_lshlrev_b32 v16, 16, v6
    v_and_b32 v17, 0xffff0000, v6
    v_mul_f32 v16, v16, v30
    v_mul_f32 v17, v17, v30
    v_lshlrev_b32 v6, 5, v0
    v_lshlrev_b32 v7, 3, v0
    ds_write_b128 v6, v[8:11] offset:256
    ds_write_b128 v6, v[12:15] offset:272
    ds_write_b64 v7, v[16:17] offset:2304
    s_waitcnt vmcnt(0) lgkmcnt(0)
    v_and_b32 v3, 15, v0
    v_lshrrev_b32 v4, 4, v0
    s_mul_i32 s12, s8, 4608
    s_add_u32 s12, s12, 57344
    v_lshlrev_b32 v5, 7, v4
    v_lshl_add_u32 v5, v3, 3, v5
    v_add_u32 v5, s12, v5
    s_lshl_b32 s12, s73, 2
    v_lshl_add_u32 v6, v4, 2, s12
    ds_read_b64 v[32:33], v5 offset:0
    ds_read_b32 v56, v6 offset:256
    ds_read_b64 v[34:35], v5 offset:512
    ds_read_b32 v57, v6 offset:272
    ds_read_b64 v[36:37], v5 offset:1024
    ds_read_b32 v58, v6 offset:288
    ds_read_b64 v[38:39], v5 offset:1536
    ds_read_b32 v59, v6 offset:304
    ds_read_b64 v[40:41], v5 offset:2048
    ds_read_b32 v60, v6 offset:320
    ds_read_b64 v[42:43], v5 offset:2560
    ds_read_b32 v61, v6 offset:336
    ds_read_b64 v[44:45], v5 offset:3072
    ds_read_b32 v62, v6 offset:352
    ds_read_b64 v[46:47], v5 offset:3584
    ds_read_b32 v63, v6 offset:368
    ds_read_b64 v[48:49], v5 offset:4096
    ds_read_b32 v64, v6 offset:384
    v_mov_b32 v20, 0
    v_mov_b32 v21, 0
    v_mov_b32 v22, 0
    v_mov_b32 v23, 0
    s_waitcnt lgkmcnt(15)
    v_lshlrev_b32 v72, 16, v32
    v_and_b32 v73, 0xffff0000, v32
    v_lshlrev_b32 v74, 16, v33
    v_and_b32 v75, 0xffff0000, v33
    v_fmac_f32 v20, v56, v72
    v_fmac_f32 v21, v56, v73
    v_fmac_f32 v22, v56, v74
    v_fmac_f32 v23, v56, v75
    s_waitcnt lgkmcnt(14)
    v_lshlrev_b32 v72, 16, v34
    v_and_b32 v73, 0xffff0000, v34
    v_lshlrev_b32 v74, 16, v35
    v_and_b32 v75, 0xffff0000, v35
    v_fmac_f32 v20, v57, v72
    v_fmac_f32 v21, v57, v73
    v_fmac_f32 v22, v57, v74
    v_fmac_f32 v23, v57, v75
    s_waitcnt lgkmcnt(12)
    v_lshlrev_b32 v72, 16, v36
    v_and_b32 v73, 0xffff0000, v36
    v_lshlrev_b32 v74, 16, v37
    v_and_b32 v75, 0xffff0000, v37
    v_fmac_f32 v20, v58, v72
    v_fmac_f32 v21, v58, v73
    v_fmac_f32 v22, v58, v74
    v_fmac_f32 v23, v58, v75
    s_waitcnt lgkmcnt(10)
    v_lshlrev_b32 v72, 16, v38
    v_and_b32 v73, 0xffff0000, v38
    v_lshlrev_b32 v74, 16, v39
    v_and_b32 v75, 0xffff0000, v39
    v_fmac_f32 v20, v59, v72
    v_fmac_f32 v21, v59, v73
    v_fmac_f32 v22, v59, v74
    v_fmac_f32 v23, v59, v75
    s_waitcnt lgkmcnt(8)
    v_lshlrev_b32 v72, 16, v40
    v_and_b32 v73, 0xffff0000, v40
    v_lshlrev_b32 v74, 16, v41
    v_and_b32 v75, 0xffff0000, v41
    v_fmac_f32 v20, v60, v72
    v_fmac_f32 v21, v60, v73
    v_fmac_f32 v22, v60, v74
    v_fmac_f32 v23, v60, v75
    s_waitcnt lgkmcnt(6)
    v_lshlrev_b32 v72, 16, v42
    v_and_b32 v73, 0xffff0000, v42
    v_lshlrev_b32 v74, 16, v43
    v_and_b32 v75, 0xffff0000, v43
    v_fmac_f32 v20, v61, v72
    v_fmac_f32 v21, v61, v73
    v_fmac_f32 v22, v61, v74
    v_fmac_f32 v23, v61, v75
    s_waitcnt lgkmcnt(4)
    v_lshlrev_b32 v72, 16, v44
    v_and_b32 v73, 0xffff0000, v44
    v_lshlrev_b32 v74, 16, v45
    v_and_b32 v75, 0xffff0000, v45
    v_fmac_f32 v20, v62, v72
    v_fmac_f32 v21, v62, v73
    v_fmac_f32 v22, v62, v74
    v_fmac_f32 v23, v62, v75
    s_waitcnt lgkmcnt(2)
    v_lshlrev_b32 v72, 16, v46
    v_and_b32 v73, 0xffff0000, v46
    v_lshlrev_b32 v74, 16, v47
    v_and_b32 v75, 0xffff0000, v47
    v_fmac_f32 v20, v63, v72
    v_fmac_f32 v21, v63, v73
    v_fmac_f32 v22, v63, v74
    v_fmac_f32 v23, v63, v75
    s_waitcnt lgkmcnt(0)
    v_lshlrev_b32 v72, 16, v48
    v_and_b32 v73, 0xffff0000, v48
    v_lshlrev_b32 v74, 16, v49
    v_and_b32 v75, 0xffff0000, v49
    v_fmac_f32 v20, v64, v72
    v_fmac_f32 v21, v64, v73
    v_fmac_f32 v22, v64, v74
    v_fmac_f32 v23, v64, v75
    s_lshl_b32 s12, s8, 10
    v_lshlrev_b32 v5, 8, v4
    v_lshl_add_u32 v5, v3, 4, v5
    v_add_u32 v5, s12, v5
    ds_write_b128 v5, v[20:23] offset:16384
    s_waitcnt lgkmcnt(0)
    v_mov_b32 v3, 0
    v_mov_b32 v4, 1
    s_mov_b64 exec, 1
    ds_add_u32 v3, v4
    s_mov_b64 exec, -1
    s_cmp_eq_u32 s8, 0
    s_cbranch_scc0 L_nos2_1
    s_mov_b32 s79, 0x40000
L_cw_2:
    v_mov_b32 v3, 0
    ds_read_b32 v3, v3
    s_waitcnt lgkmcnt(0)
    v_readfirstlane_b32 s78, v3
    s_cmp_ge_u32 s78, 4
    s_cbranch_scc1 L_cwd_3

    s_sub_u32 s79, s79, 1
    s_cmp_lg_u32 s79, 0
    s_cbranch_scc1 L_cw_2
L_cwd_3:
    v_and_b32 v3, 15, v0
    v_lshlrev_b32 v3, 4, v3
    v_lshrrev_b32 v4, 4, v0
    v_lshl_add_u32 v3, v4, 10, v3
    ds_read_b128 v[20:23], v3 offset:16384
    ds_read_b128 v[32:35], v3 offset:16640
    ds_read_b128 v[36:39], v3 offset:16896
    ds_read_b128 v[40:43], v3 offset:17152
    s_waitcnt lgkmcnt(0)
    v_add_f32 v20, v20, v32
    v_add_f32 v36, v36, v40
    v_add_f32 v21, v21, v33
    v_add_f32 v37, v37, v41
    v_add_f32 v22, v22, v34
    v_add_f32 v38, v38, v42
    v_add_f32 v23, v23, v35
    v_add_f32 v39, v39, v43
    v_add_f32 v20, v20, v36
    v_add_f32 v21, v21, v37
    v_add_f32 v22, v22, v38
    v_add_f32 v23, v23, v39
    v_mov_b32 v32, v20
    v_mov_b32 v33, v21
    v_mov_b32 v34, v22
    v_mov_b32 v35, v23
    s_nop 1
    v_permlane16_swap_b32 v20, v32
    v_permlane16_swap_b32 v21, v33
    v_permlane16_swap_b32 v22, v34
    v_permlane16_swap_b32 v23, v35
    v_add_f32 v20, v20, v32
    v_add_f32 v21, v21, v33
    v_add_f32 v22, v22, v34
    v_add_f32 v23, v23, v35
    v_mov_b32 v32, v20
    v_mov_b32 v33, v21
    v_mov_b32 v34, v22
    v_mov_b32 v35, v23
    s_nop 1
    v_permlane32_swap_b32 v20, v32
    v_permlane32_swap_b32 v21, v33
    v_permlane32_swap_b32 v22, v34
    v_permlane32_swap_b32 v23, v35
    v_add_f32 v20, v20, v32
    v_add_f32 v21, v21, v33
    v_add_f32 v22, v22, v34
    v_add_f32 v23, v23, v35
    v_and_or_b32 v20, v20, v1, s64
    v_and_or_b32 v21, v21, v1, s65
    v_and_or_b32 v22, v22, v1, s66
    v_and_or_b32 v23, v23, v1, s67
    s_lshr_b32 s11, s5, 2
    s_lshl_b32 s11, s11, 14
    s_lshl_b32 s12, s4, 10
    s_add_u32 s11, s11, s12
    s_and_b32 s12, s5, 3
    s_lshl_b32 s12, s12, 8
    s_add_u32 s11, s11, s12
    s_add_u32 s11, s11, 4096
    s_mov_b32 exec_lo, 0xffff
    s_mov_b32 exec_hi, 0x0
    buffer_store_dwordx4 v[20:23], v2, s[44:47], s11 offen sc1
    s_mov_b64 exec, -1
L_nos2_1:
    s_lshl_b32 s11, s4, 10
    s_lshl_b32 s12, s8, 8
    s_add_u32 s11, s11, s12
    s_add_u32 s11, s11, 4096
    v_lshrrev_b32 v4, 4, v0
    v_lshlrev_b32 v4, 14, v4
    v_and_b32 v5, 15, v0
    v_lshl_add_u32 v4, v5, 4, v4
    s_mov_b32 s79, 0x40000
    buffer_load_dwordx4 v[48:51], v4, s[44:47], s11 offen sc1
    s_sleep 2
L_h1p_6:
    s_waitcnt vmcnt(0)
    v_xor_b32 v40, s64, v48
    v_xor_b32 v41, s65, v49
    v_xor_b32 v42, s66, v50
    v_or3_b32 v40, v40, v41, v42
    v_xor_b32 v41, s67, v51
    v_or_b32 v40, v40, v41
    v_and_b32 v40, 0xff, v40
    v_cmp_ne_u32 vcc, 0, v40
    s_nop 1
    s_cbranch_vccz L_h1pok_8
    buffer_load_dwordx4 v[48:51], v4, s[44:47], s11 offen sc1
    s_sub_u32 s79, s79, 1
    s_cmp_lg_u32 s79, 0
    s_cbranch_scc1 L_h1p_6
L_h1pok_8:
    v_mov_b32 v32, v48
    v_mov_b32 v33, v49
    v_mov_b32 v34, v50
    v_mov_b32 v35, v51
L_h1pd_7:
    v_and_b32 v32, v1, v32
    v_and_b32 v33, v1, v33
    v_and_b32 v34, v1, v34
    v_and_b32 v35, v1, v35
    v_mov_b32 v36, v32
    v_mov_b32 v37, v33
    v_mov_b32 v38, v34
    v_mov_b32 v39, v35
    s_nop 1
    v_permlane16_swap_b32 v32, v36
    v_permlane16_swap_b32 v33, v37
    v_permlane16_swap_b32 v34, v38
    v_permlane16_swap_b32 v35, v39
    v_add_f32 v32, v32, v36
    v_add_f32 v33, v33, v37
    v_add_f32 v34, v34, v38
    v_add_f32 v35, v35, v39
    v_mov_b32 v36, v32
    v_mov_b32 v37, v33
    v_mov_b32 v38, v34
    v_mov_b32 v39, v35
    s_nop 1
    v_permlane32_swap_b32 v32, v36
    v_permlane32_swap_b32 v33, v37
    v_permlane32_swap_b32 v34, v38
    v_permlane32_swap_b32 v35, v39
    v_add_f32 v32, v32, v36
    v_add_f32 v33, v33, v37
    v_add_f32 v34, v34, v38
    v_add_f32 v35, v35, v39
    v_cvt_pk_bf16_f32 v32, v32, v33
    v_cvt_pk_bf16_f32 v33, v34, v35
    v_lshlrev_b32 v5, 3, v5
    s_lshl_b32 s12, s8, 7
    v_add_u32 v5, s12, v5
    s_mov_b32 exec_lo, 0xffff
    s_mov_b32 exec_hi, 0x0
    ds_write_b64 v5, v[32:33] offset:5376
    s_mov_b64 exec, -1
    s_waitcnt lgkmcnt(0)
    v_mov_b32 v3, 4
    v_mov_b32 v4, 1
    s_mov_b64 exec, 1
    ds_add_u32 v3, v4
    s_mov_b64 exec, -1
    s_cmp_eq_u32 s8, 1
    s_cbranch_scc0 L_hq_noml
    s_mov_b32 s79, 0x40000
L_cw_9:
    v_mov_b32 v3, 32
    ds_read_b32 v3, v3
    s_waitcnt lgkmcnt(0)
    v_readfirstlane_b32 s78, v3
    s_cmp_ge_u32 s78, 8
    s_cbranch_scc1 L_cwd_10
    s_sleep 3
    s_sub_u32 s79, s79, 1
    s_cmp_lg_u32 s79, 0
    s_cbranch_scc1 L_cw_9
L_cwd_10:
    s_waitcnt vmcnt(0)
    v_lshrrev_b32 v4, 5, v0
    v_lshlrev_b32 v4, 5, v4
    ds_read_b128 v[48:51], v4 offset:5952
    ds_read_b128 v[52:55], v4 offset:5968
    ds_read_b128 v[56:59], v4 offset:5888
    ds_read_b128 v[60:63], v4 offset:5904
    s_waitcnt lgkmcnt(0)
    v_add_f32 v13, v48, v49
    v_add_f32 v14, v50, v51
    v_add_f32 v15, v52, v53
    v_add_f32 v13, v13, v14
    v_add_f32 v14, v54, v55
    v_add_f32 v13, v13, v15
    v_add_f32 v13, v13, v14
    v_max3_f32 v12, v56, v57, v58
    v_max3_f32 v12, v12, v59, v60
    v_max3_f32 v12, v12, v61, v62
    v_max_f32 v12, v12, v63
    v_mov_b32 v14, 0
    v_mov_b32 v15, 0
    v_and_or_b32 v12, v12, v1, s64
    v_and_or_b32 v13, v13, v1, s65
    v_and_or_b32 v14, v14, v1, s66
    v_and_or_b32 v15, v15, v1, s67
    v_lshlrev_b32 v4, 3, v4
    s_lshl_b32 s12, s4, 9
    s_lshl_b32 s13, s5, 4
    s_add_u32 s12, s12, s13
    s_add_u32 s12, s12, 393216
    s_mov_b32 exec_lo, 0x1
    s_mov_b32 exec_hi, 0x1
    buffer_store_dwordx4 v[12:15], v4, s[44:47], s12 offen sc1
    s_mov_b64 exec, -1
L_hq_noml:
    s_cmp_eq_u32 s8, 0
    s_cbranch_scc1 L_hq0
    s_sub_u32 s9, s8, 1
    s_cmp_eq_u32 s9, 2
    s_cselect_b32 s12, s7, 0
    s_cmp_lg_u32 s12, 0
    s_cbranch_scc1 L_done
    s_cmp_eq_u32 s9, 2
    s_cselect_b32 s68, 0x00ff00ff, -1
    v_and_b32 v4, 7, v0
    v_lshrrev_b32 v5, 1, v4
    v_and_b32 v4, 1, v4
    v_mov_b32 v6, 0xffff
    v_mov_b32 v7, 0xffff0000
    v_cmp_eq_u32 vcc, 1, v4
    s_nop 1
    v_cndmask_b32 v6, v6, v7, vcc
    v_and_b32 v4, 8, v0
    v_cmp_eq_u32 vcc, 0, v4
    s_nop 1
    v_cndmask_b32 v6, 0, v6, vcc
    v_cmp_eq_u32 vcc, 0, v5
    s_nop 1
    v_cndmask_b32 v112, 0, v6, vcc
    v_cmp_eq_u32 vcc, 1, v5
    s_nop 1
    v_cndmask_b32 v113, 0, v6, vcc
    v_cmp_eq_u32 vcc, 2, v5
    s_nop 1
    v_cndmask_b32 v114, 0, v6, vcc
    v_cmp_eq_u32 vcc, 3, v5
    s_nop 1
    v_cndmask_b32 v115, 0, v6, vcc
    s_waitcnt vmcnt(0)
    s_mov_b32 s79, 0x40000
L_cw_11:
    v_mov_b32 v3, 20
    ds_read_b32 v3, v3
    s_waitcnt lgkmcnt(0)
    v_readfirstlane_b32 s78, v3
    s_cmp_ge_u32 s78, 8
    s_cbranch_scc1 L_cwd_12
    s_sleep 2
    s_sub_u32 s79, s79, 1
    s_cmp_lg_u32 s79, 0
    s_cbranch_scc1 L_cw_11
L_cwd_12:
    s_lshl_b32 s11, s6, 5
    s_mul_i32 s11, s11, 1152
    s_add_u32 s11, s11, s72
    s_lshl_b32 s12, s9, 8
    s_add_u32 s11, s11, s12
    v_lshrrev_b32 v4, 4, v0
    v_mul_u32_u24 v4, 1152, v4
    v_and_b32 v5, 15, v0
    v_lshl_add_u32 v4, v5, 4, v4
    s_mov_b32 exec_lo, s68
    s_mov_b32 exec_hi, s68
    buffer_load_dwordx4 v[32:35], v4, s[60:63], s11 offen nt
    s_add_u32 s11, s11, 4608
    buffer_load_dwordx4 v[36:39], v4, s[60:63], s11 offen nt
    s_add_u32 s11, s11, 4608
    buffer_load_dwordx4 v[40:43], v4, s[60:63], s11 offen nt
    s_add_u32 s11, s11, 4608
    buffer_load_dwordx4 v[44:47], v4, s[60:63], s11 offen nt
    s_add_u32 s11, s11, 4608
    buffer_load_dwordx4 v[48:51], v4, s[60:63], s11 offen nt
    s_add_u32 s11, s11, 4608
    buffer_load_dwordx4 v[52:55], v4, s[60:63], s11 offen nt
    s_add_u32 s11, s11, 4608
    buffer_load_dwordx4 v[56:59], v4, s[60:63], s11 offen nt
    s_add_u32 s11, s11, 4608
    buffer_load_dwordx4 v[60:63], v4, s[60:63], s11 offen nt
    s_add_u32 s11, s11, 4608
    s_mov_b64 exec, -1
    s_mov_b32 s79, 0x40000
L_cw_13:
    v_mov_b32 v3, 44
    ds_read_b32 v3, v3
    s_waitcnt lgkmcnt(0)
    v_readfirstlane_b32 s78, v3
    s_cmp_ge_u32 s78, 1
    s_cbranch_scc1 L_cwd_14

    s_sub_u32 s79, s79, 1
    s_cmp_lg_u32 s79, 0
    s_cbranch_scc1 L_cw_13
L_cwd_14:
    v_lshrrev_b32 v3, 4, v0
    v_lshlrev_b32 v3, 2, v3
    ds_read_b32 v72, v3 offset:6400
    ds_read_b32 v73, v3 offset:6416
    ds_read_b32 v74, v3 offset:6432
    ds_read_b32 v75, v3 offset:6448
    ds_read_b32 v76, v3 offset:6464
    ds_read_b32 v77, v3 offset:6480
    ds_read_b32 v78, v3 offset:6496
    ds_read_b32 v79, v3 offset:6512
    v_mov_b32 v8, 0
    v_mov_b32 v9, 0
    v_mov_b32 v10, 0
    v_mov_b32 v11, 0
    s_waitcnt vmcnt(0) lgkmcnt(0)
    v_cvt_pk_bf16_f32 v72, v72, v72
    v_and_b32 v16, v72, v112
    v_and_b32 v17, v72, v113
    v_and_b32 v18, v72, v114
    v_and_b32 v19, v72, v115
    s_nop 1
    v_mfma_f32_16x16x32_bf16 v[8:11], v[16:19], v[32:35], v[8:11]
    v_cvt_pk_bf16_f32 v73, v73, v73
    v_and_b32 v20, v73, v112
    v_and_b32 v21, v73, v113
    v_and_b32 v22, v73, v114
    v_and_b32 v23, v73, v115
    s_nop 1
    v_mfma_f32_16x16x32_bf16 v[8:11], v[20:23], v[36:39], v[8:11]
    v_cvt_pk_bf16_f32 v74, v74, v74
    v_and_b32 v24, v74, v112
    v_and_b32 v25, v74, v113
    v_and_b32 v26, v74, v114
    v_and_b32 v27, v74, v115
    s_nop 1
    v_mfma_f32_16x16x32_bf16 v[8:11], v[24:27], v[40:43], v[8:11]
    v_cvt_pk_bf16_f32 v75, v75, v75
    v_and_b32 v16, v75, v112
    v_and_b32 v17, v75, v113
    v_and_b32 v18, v75, v114
    v_and_b32 v19, v75, v115
    s_nop 1
    v_mfma_f32_16x16x32_bf16 v[8:11], v[16:19], v[44:47], v[8:11]
    v_cvt_pk_bf16_f32 v76, v76, v76
    v_and_b32 v20, v76, v112
    v_and_b32 v21, v76, v113
    v_and_b32 v22, v76, v114
    v_and_b32 v23, v76, v115
    s_nop 1
    v_mfma_f32_16x16x32_bf16 v[8:11], v[20:23], v[48:51], v[8:11]
    v_cvt_pk_bf16_f32 v77, v77, v77
    v_and_b32 v24, v77, v112
    v_and_b32 v25, v77, v113
    v_and_b32 v26, v77, v114
    v_and_b32 v27, v77, v115
    s_nop 1
    v_mfma_f32_16x16x32_bf16 v[8:11], v[24:27], v[52:55], v[8:11]
    v_cvt_pk_bf16_f32 v78, v78, v78
    v_and_b32 v16, v78, v112
    v_and_b32 v17, v78, v113
    v_and_b32 v18, v78, v114
    v_and_b32 v19, v78, v115
    s_nop 1
    v_mfma_f32_16x16x32_bf16 v[8:11], v[16:19], v[56:59], v[8:11]
    v_cvt_pk_bf16_f32 v79, v79, v79
    v_and_b32 v20, v79, v112
    v_and_b32 v21, v79, v113
    v_and_b32 v22, v79, v114
    v_and_b32 v23, v79, v115
    s_nop 1
    v_mfma_f32_16x16x32_bf16 v[8:11], v[20:23], v[60:63], v[8:11]
    v_and_b32 v4, 15, v0
    v_lshlrev_b32 v4, 5, v4
    v_lshrrev_b32 v5, 4, v0
    v_lshl_add_u32 v4, v5, 4, v4
    s_mul_i32 s11, s6, 2304
    s_lshl_b32 s12, s72, 1
    s_add_u32 s11, s11, s12
    s_lshl_b32 s12, s9, 9
    s_add_u32 s11, s11, s12
    s_add_u32 s11, s11, 409600
    s_nop 3
    v_and_or_b32 v8, v8, v1, s64
    v_and_or_b32 v9, v9, v1, s65
    v_and_or_b32 v10, v10, v1, s66
    v_and_or_b32 v11, v11, v1, s67
    s_mov_b32 exec_lo, s68
    s_mov_b32 exec_hi, 0
    buffer_store_dwordx4 v[8:11], v4, s[44:47], s11 offen sc1
    s_mov_b64 exec, -1
    s_branch L_done
L_hq0:
    s_lshl_b32 s12, s6, 11
    s_add_u32 s12, s12, 131072
    s_lshr_b32 s13, s6, 2
    s_lshl_b32 s13, s13, 8
    s_add_u32 s13, s13, 393216
    v_lshrrev_b32 v3, 3, v0
    v_lshlrev_b32 v3, 4, v3
    v_lshrrev_b32 v5, 4, v0
    v_and_b32 v6, 1, v5
    v_lshrrev_b32 v5, 1, v5
    v_lshl_add_u32 v5, v6, 1, v5
    v_and_b32 v6, 7, v0
    v_lshl_add_u32 v5, v6, 2, v5
    v_lshlrev_b32 v5, 2, v5
    s_mov_b32 s10, 0x3fb8aa3b
    s_mov_b32 s79, 0x40000
L_cw_17:
    v_mov_b32 v7, 20
    ds_read_b32 v7, v7
    s_waitcnt lgkmcnt(0)
    v_readfirstlane_b32 s78, v7
    s_cmp_ge_u32 s78, 8
    s_cbranch_scc1 L_cwd_18
    s_sleep 1
    s_sub_u32 s79, s79, 1
    s_cmp_lg_u32 s79, 0
    s_cbranch_scc1 L_cw_17
L_cwd_18:
    s_mov_b32 s79, 0x40000
L_h2poll_15:
    buffer_load_dwordx4 v[24:27], v3, s[44:47], s13 offen sc1
    buffer_load_dwordx4 v[28:31], v3, s[44:47], s13 offen offset:128 sc1
    buffer_load_dwordx4 v[16:19], v2, s[44:47], s12 offen sc1
    buffer_load_dwordx4 v[20:23], v2, s[44:47], s12 offen offset:1024 sc1
    s_waitcnt vmcnt(0)
    v_xor_b32 v32, s64, v16
    v_xor_b32 v33, s65, v17
    v_xor_b32 v34, s66, v18
    v_or3_b32 v32, v32, v33, v34
    v_xor_b32 v33, s67, v19
    v_or_b32 v32, v32, v33
    v_xor_b32 v33, s64, v20
    v_xor_b32 v34, s65, v21
    v_or3_b32 v32, v32, v33, v34
    v_xor_b32 v33, s66, v22
    v_xor_b32 v34, s67, v23
    v_or3_b32 v32, v32, v33, v34
    v_xor_b32 v33, s64, v24
    v_xor_b32 v34, s65, v25
    v_or3_b32 v32, v32, v33, v34
    v_xor_b32 v33, s66, v26
    v_xor_b32 v34, s67, v27
    v_or3_b32 v32, v32, v33, v34
    v_xor_b32 v33, s64, v28
    v_xor_b32 v34, s65, v29
    v_or3_b32 v32, v32, v33, v34
    v_xor_b32 v33, s66, v30
    v_xor_b32 v34, s67, v31
    v_or3_b32 v32, v32, v33, v34
    v_and_b32 v32, 0xff, v32
    v_cmp_ne_u32 vcc, 0, v32
    s_nop 1
    s_cbranch_vccz L_h2done_16

    s_sub_u32 s79, s79, 1
    s_cmp_lg_u32 s79, 0
    s_cbranch_scc1 L_h2poll_15
L_h2done_16:
    v_and_b32 v24, v1, v24
    v_and_b32 v28, v1, v28
    v_max_f32 v32, v24, v28
    v_and_b32 v25, v1, v25
    v_and_b32 v29, v1, v29
    v_max_f32_dpp v32, v32, v32 row_ror:8 row_mask:0xf bank_mask:0xf
    v_mov_b32 v33, v32
    v_and_b32 v16, v1, v16
    v_and_b32 v17, v1, v17
    v_permlane16_swap_b32 v32, v33
    v_max_f32 v32, v32, v33
    v_mov_b32 v33, v32
    v_and_b32 v18, v1, v18
    v_and_b32 v19, v1, v19
    v_permlane32_swap_b32 v32, v33
    v_max_f32 v32, v32, v33
    v_sub_f32 v24, v24, v32
    v_sub_f32 v28, v28, v32
    v_mul_f32 v24, s10, v24
    v_mul_f32 v28, s10, v28
    v_exp_f32 v24, v24
    v_exp_f32 v28, v28
    v_and_b32 v20, v1, v20
    v_and_b32 v21, v1, v21
    v_and_b32 v22, v1, v22
    v_and_b32 v23, v1, v23
    v_mul_f32 v34, v24, v25
    v_fmac_f32 v34, v28, v29
    v_mul_f32 v16, v24, v16
    v_fmac_f32 v16, v28, v20
    v_mul_f32 v17, v24, v17
    v_fmac_f32 v17, v28, v21
    v_mul_f32 v18, v24, v18
    v_fmac_f32 v18, v28, v22
    v_mul_f32 v19, v24, v19
    v_fmac_f32 v19, v28, v23
    v_add_f32_dpp v34, v34, v34 row_ror:8 row_mask:0xf bank_mask:0xf
    v_permlane32_swap_b32 v16, v17
    v_permlane32_swap_b32 v18, v19
    v_mov_b32 v35, v34
    v_add_f32 v16, v16, v17
    v_add_f32 v18, v18, v19
    v_permlane16_swap_b32 v34, v35
    v_add_f32 v34, v34, v35
    v_permlane16_swap_b32 v16, v18
    v_mov_b32 v35, v34
    v_add_f32 v16, v16, v18
    s_nop 0
    v_permlane32_swap_b32 v34, v35
    v_add_f32 v34, v34, v35
    v_add_f32_dpp v16, v16, v16 row_ror:8 row_mask:0xf bank_mask:0xf
    v_rcp_f32 v35, v34
    s_nop 0
    v_mul_f32 v20, v16, v35
    v_fma_f32 v21, -v20, v34, v16
    v_fma_f32 v16, v21, v35, v20
    v_cvt_pk_bf16_f32 v16, v16, v16
    v_lshlrev_b32 v16, 16, v16
    s_mov_b32 s14, 0x00ff00ff
    s_mov_b32 s15, 0x00ff00ff
    s_mov_b64 exec, s[14:15]
    ds_write_b32 v5, v16 offset:6400
    s_mov_b64 exec, -1
    s_waitcnt lgkmcnt(0)
    v_mov_b32 v3, 44
    v_mov_b32 v4, 1
    s_mov_b64 exec, 1
    ds_add_u32 v3, v4
    s_mov_b64 exec, -1
    s_branch L_done
L_hh:
    s_getpc_b64 s[76:77]
L_pc:
    s_sub_u32 s76, s76, L_pc-parallel_sum__sliding_block_cached__mixer_channel_mlp__decode_kernel
    s_subb_u32 s77, s77, 0
    s_lshl_b32 s9, s8, 12
    v_add_u32 v4, s9, v2
    global_load_dwordx4 v[100:103], v4, s[76:77]
    global_load_dwordx4 v[104:107], v4, s[76:77] offset:1024
    global_load_dwordx4 v[108:111], v4, s[76:77] offset:2048
    s_cmp_eq_u32 s8, 3
    s_cselect_b32 s9, 0, 3072
    v_add_u32 v4, s9, v4
    global_load_dwordx4 v[112:115], v4, s[76:77]
    s_mov_b32 s56, s28
    s_and_b32 s57, s29, 0xffff
    s_mov_b32 s58, 5308416
    s_mov_b32 s59, 0x00020000
    s_mov_b32 s52, s32
    s_and_b32 s53, s33, 0xffff
    s_mov_b32 s54, 5308416
    s_mov_b32 s55, 0x00020000
    s_mov_b32 s56, s28
    s_and_b32 s57, s29, 0xffff
    s_mov_b32 s58, 5308416
    s_mov_b32 s59, 0x00020000
    s_mov_b32 s75, 0
    s_cmp_ge_u32 s2, 216
    s_cbranch_scc1 L_hh_noth0
    s_mul_i32 s9, s2, 43691
    s_lshr_b32 s9, s9, 17
    s_mul_i32 s10, s9, 3
    s_sub_u32 s10, s2, s10
    s_mul_i32 s11, s10, 192
    s_mul_i32 s12, s8, 48
    s_add_u32 s73, s11, s12
    s_mul_i32 s11, s73, 9216
    s_lshl_b32 s12, s9, 7
    s_add_u32 s11, s11, s12
    v_lshrrev_b32 v4, 3, v0
    s_mov_b32 s14, 9216
    v_mul_lo_u32 v4, v4, s14
    v_and_b32 v5, 7, v0
    v_lshl_add_u32 v4, v5, 4, v4
    s_mul_i32 s12, s8, 6144
    s_add_u32 s12, s12, 75776
    s_mov_b32 m0, s12
    s_nop 0
    buffer_load_dwordx4 v4, s[56:59], s11 offen nt lds
    s_add_u32 s11, s11, 73728
    s_add_u32 s12, s12, 1024
    s_mov_b32 m0, s12
    s_nop 0
    buffer_load_dwordx4 v4, s[56:59], s11 offen nt lds
    s_add_u32 s11, s11, 73728
    s_add_u32 s12, s12, 1024
    s_mov_b32 m0, s12
    s_nop 0
    buffer_load_dwordx4 v4, s[56:59], s11 offen nt lds
    s_add_u32 s11, s11, 73728
    s_add_u32 s12, s12, 1024
    s_mov_b32 m0, s12
    s_nop 0
    buffer_load_dwordx4 v4, s[56:59], s11 offen nt lds
    s_add_u32 s11, s11, 73728
    s_add_u32 s12, s12, 1024
    s_mov_b32 m0, s12
    s_nop 0
    buffer_load_dwordx4 v4, s[56:59], s11 offen nt lds
    s_add_u32 s11, s11, 73728
    s_add_u32 s12, s12, 1024
    s_mov_b32 m0, s12
    s_nop 0
    buffer_load_dwordx4 v4, s[56:59], s11 offen nt lds
    s_add_u32 s11, s11, 73728
    s_add_u32 s12, s12, 1024
L_hh_noth0:
    s_mul_i32 s11, s6, 36
    s_mul_i32 s12, s8, 9
    s_add_u32 s11, s11, s12
    s_mul_i32 s11, s11, 1152
    s_add_u32 s74, s11, s72
    s_waitcnt lgkmcnt(0)
    s_barrier
    s_add_u32 s42, s42, 1
    s_and_b32 s64, s42, 0xff
    s_bfe_u32 s65, s42, 0x80008
    s_bfe_u32 s66, s42, 0x80010
    s_lshr_b32 s67, s42, 24
    s_add_u32 s65, s65, s64
    s_add_u32 s66, s66, s64
    s_add_u32 s67, s67, s64
    s_and_b32 s65, s65, 0xff
    s_and_b32 s66, s66, 0xff
    s_and_b32 s67, s67, 0xff
    s_cmp_ge_u32 s2, 216
    s_cbranch_scc1 L_hh_x2
    s_waitcnt vmcnt(10)
    s_branch L_hh_x3
L_hh_x2:
    s_waitcnt vmcnt(4)
L_hh_x3:
    v_cmp_gt_u32 vcc, 32, v0
    v_mov_b32 v30, 0
    v_mov_b32 v31, 1.0
    s_nop 0
    v_cndmask_b32 v30, v30, v31, vcc
    s_waitcnt vmcnt(63)
    v_lshlrev_b32 v8, 16, v24
    v_and_b32 v9, 0xffff0000, v24
    v_lshlrev_b32 v10, 16, v25
    v_and_b32 v11, 0xffff0000, v25
    v_lshlrev_b32 v12, 16, v26
    v_and_b32 v13, 0xffff0000, v26
    v_lshlrev_b32 v14, 16, v27
    v_and_b32 v15, 0xffff0000, v27
    v_lshlrev_b32 v16, 16, v28
    v_and_b32 v17, 0xffff0000, v28
    v_add_f32 v4, v8, v9
    v_add_f32 v4, v4, v10
    v_add_f32 v4, v4, v11
    v_add_f32 v4, v4, v12
    v_add_f32 v4, v4, v13
    v_add_f32 v4, v4, v14
    v_add_f32 v4, v4, v15
    v_add_f32 v4, v4, v16
    v_add_f32 v4, v4, v17
    s_nop 1
    v_add_f32_dpp v4, v4, v4 row_ror:8 row_mask:0xf bank_mask:0xf
    s_nop 1
    v_add_f32_dpp v4, v4, v4 row_ror:4 row_mask:0xf bank_mask:0xf
    s_nop 1
    v_add_f32_dpp v4, v4, v4 row_ror:2 row_mask:0xf bank_mask:0xf
    s_nop 1
    v_add_f32_dpp v4, v4, v4 row_ror:1 row_mask:0xf bank_mask:0xf
    s_nop 0
    v_readlane_b32 s80, v4, 0
    v_readlane_b32 s81, v4, 16
    v_readlane_b32 s82, v4, 32
    v_readlane_b32 s83, v4, 48
    v_mov_b32 v4, s80
    v_add_f32 v4, s81, v4
    v_add_f32 v4, s82, v4
    v_add_f32 v4, s83, v4
    s_mov_b32 s10, 0x3ae38e39
    v_mul_f32 v4, s10, v4
    v_mov_b32 v5, 0
    v_sub_f32 v6, v8, v4
    v_fmac_f32 v5, v6, v6
    v_sub_f32 v6, v9, v4
    v_fmac_f32 v5, v6, v6
    v_sub_f32 v6, v10, v4
    v_fmac_f32 v5, v6, v6
    v_sub_f32 v6, v11, v4
    v_fmac_f32 v5, v6, v6
    v_sub_f32 v6, v12, v4
    v_fmac_f32 v5, v6, v6
    v_sub_f32 v6, v13, v4
    v_fmac_f32 v5, v6, v6
    v_sub_f32 v6, v14, v4
    v_fmac_f32 v5, v6, v6
    v_sub_f32 v6, v15, v4
    v_fmac_f32 v5, v6, v6
    v_sub_f32 v6, v16, v4
    v_mul_f32 v6, v6, v30
    v_fmac_f32 v5, v6, v6
    v_sub_f32 v6, v17, v4
    v_mul_f32 v6, v6, v30
    v_fmac_f32 v5, v6, v6
    s_nop 1
    v_add_f32_dpp v5, v5, v5 row_ror:8 row_mask:0xf bank_mask:0xf
    s_nop 1
    v_add_f32_dpp v5, v5, v5 row_ror:4 row_mask:0xf bank_mask:0xf
    s_nop 1
    v_add_f32_dpp v5, v5, v5 row_ror:2 row_mask:0xf bank_mask:0xf
    s_nop 1
    v_add_f32_dpp v5, v5, v5 row_ror:1 row_mask:0xf bank_mask:0xf
    s_nop 0
    v_readlane_b32 s80, v5, 0
    v_readlane_b32 s81, v5, 16
    v_readlane_b32 s82, v5, 32
    v_readlane_b32 s83, v5, 48
    v_mov_b32 v5, s80
    v_add_f32 v5, s81, v5
    v_add_f32 v5, s82, v5
    v_add_f32 v5, s83, v5
    v_mul_f32 v5, s10, v5
    v_cvt_pk_bf16_f32 v6, v4, v5
    v_lshlrev_b32 v4, 16, v6
    v_and_b32 v5, 0xffff0000, v6
    v_add_f32 v5, 0x3727c5ac, v5
    v_cvt_pk_bf16_f32 v5, v5, v5
    v_lshlrev_b32 v5, 16, v5
    v_sqrt_f32 v5, v5
    s_nop 0
    v_cvt_pk_bf16_f32 v5, v5, v5
    v_lshlrev_b32 v5, 16, v5
    v_rcp_f32 v7, v5
    s_nop 0
    v_sub_f32 v8, v8, v4
    v_sub_f32 v9, v9, v4
    v_cvt_pk_bf16_f32 v6, v8, v9
    v_lshlrev_b32 v8, 16, v6
    v_and_b32 v9, 0xffff0000, v6
    v_mul_f32 v6, v8, v7
    v_fma_f32 v8, -v6, v5, v8
    v_fma_f32 v8, v8, v7, v6
    v_mul_f32 v6, v9, v7
    v_fma_f32 v9, -v6, v5, v9
    v_fma_f32 v9, v9, v7, v6
    v_cvt_pk_bf16_f32 v6, v8, v9
    v_lshlrev_b32 v8, 16, v6
    v_and_b32 v9, 0xffff0000, v6
    v_sub_f32 v10, v10, v4
    v_sub_f32 v11, v11, v4
    v_cvt_pk_bf16_f32 v6, v10, v11
    v_lshlrev_b32 v10, 16, v6
    v_and_b32 v11, 0xffff0000, v6
    v_mul_f32 v6, v10, v7
    v_fma_f32 v10, -v6, v5, v10
    v_fma_f32 v10, v10, v7, v6
    v_mul_f32 v6, v11, v7
    v_fma_f32 v11, -v6, v5, v11
    v_fma_f32 v11, v11, v7, v6
    v_cvt_pk_bf16_f32 v6, v10, v11
    v_lshlrev_b32 v10, 16, v6
    v_and_b32 v11, 0xffff0000, v6
    v_sub_f32 v12, v12, v4
    v_sub_f32 v13, v13, v4
    v_cvt_pk_bf16_f32 v6, v12, v13
    v_lshlrev_b32 v12, 16, v6
    v_and_b32 v13, 0xffff0000, v6
    v_mul_f32 v6, v12, v7
    v_fma_f32 v12, -v6, v5, v12
    v_fma_f32 v12, v12, v7, v6
    v_mul_f32 v6, v13, v7
    v_fma_f32 v13, -v6, v5, v13
    v_fma_f32 v13, v13, v7, v6
    v_cvt_pk_bf16_f32 v6, v12, v13
    v_lshlrev_b32 v12, 16, v6
    v_and_b32 v13, 0xffff0000, v6
    v_sub_f32 v14, v14, v4
    v_sub_f32 v15, v15, v4
    v_cvt_pk_bf16_f32 v6, v14, v15
    v_lshlrev_b32 v14, 16, v6
    v_and_b32 v15, 0xffff0000, v6
    v_mul_f32 v6, v14, v7
    v_fma_f32 v14, -v6, v5, v14
    v_fma_f32 v14, v14, v7, v6
    v_mul_f32 v6, v15, v7
    v_fma_f32 v15, -v6, v5, v15
    v_fma_f32 v15, v15, v7, v6
    v_cvt_pk_bf16_f32 v6, v14, v15
    v_lshlrev_b32 v14, 16, v6
    v_and_b32 v15, 0xffff0000, v6
    v_sub_f32 v16, v16, v4
    v_sub_f32 v17, v17, v4
    v_cvt_pk_bf16_f32 v6, v16, v17
    v_lshlrev_b32 v16, 16, v6
    v_and_b32 v17, 0xffff0000, v6
    v_mul_f32 v6, v16, v7
    v_fma_f32 v16, -v6, v5, v16
    v_fma_f32 v16, v16, v7, v6
    v_mul_f32 v6, v17, v7
    v_fma_f32 v17, -v6, v5, v17
    v_fma_f32 v17, v17, v7, v6
    v_cvt_pk_bf16_f32 v6, v16, v17
    v_lshlrev_b32 v16, 16, v6
    v_and_b32 v17, 0xffff0000, v6
    v_mul_f32 v16, v16, v30
    v_mul_f32 v17, v17, v30
    v_add_f32 v4, v8, v9
    v_add_f32 v4, v4, v10
    v_add_f32 v4, v4, v11
    v_add_f32 v4, v4, v12
    v_add_f32 v4, v4, v13
    v_add_f32 v4, v4, v14
    v_add_f32 v4, v4, v15
    v_add_f32 v4, v4, v16
    v_add_f32 v4, v4, v17
    s_nop 1
    v_add_f32_dpp v4, v4, v4 row_ror:8 row_mask:0xf bank_mask:0xf
    s_nop 1
    v_add_f32_dpp v4, v4, v4 row_ror:4 row_mask:0xf bank_mask:0xf
    s_nop 1
    v_add_f32_dpp v4, v4, v4 row_ror:2 row_mask:0xf bank_mask:0xf
    s_nop 1
    v_add_f32_dpp v4, v4, v4 row_ror:1 row_mask:0xf bank_mask:0xf
    s_nop 0
    v_readlane_b32 s80, v4, 0
    v_readlane_b32 s81, v4, 16
    v_readlane_b32 s82, v4, 32
    v_readlane_b32 s83, v4, 48
    v_mov_b32 v4, s80
    v_add_f32 v4, s81, v4
    v_add_f32 v4, s82, v4
    v_add_f32 v4, s83, v4
    s_mov_b32 s10, 0x3ae38e39
    v_mul_f32 v4, s10, v4
    v_mov_b32 v5, 0
    v_sub_f32 v6, v8, v4
    v_fmac_f32 v5, v6, v6
    v_sub_f32 v6, v9, v4
    v_fmac_f32 v5, v6, v6
    v_sub_f32 v6, v10, v4
    v_fmac_f32 v5, v6, v6
    v_sub_f32 v6, v11, v4
    v_fmac_f32 v5, v6, v6
    v_sub_f32 v6, v12, v4
    v_fmac_f32 v5, v6, v6
    v_sub_f32 v6, v13, v4
    v_fmac_f32 v5, v6, v6
    v_sub_f32 v6, v14, v4
    v_fmac_f32 v5, v6, v6
    v_sub_f32 v6, v15, v4
    v_fmac_f32 v5, v6, v6
    v_sub_f32 v6, v16, v4
    v_mul_f32 v6, v6, v30
    v_fmac_f32 v5, v6, v6
    v_sub_f32 v6, v17, v4
    v_mul_f32 v6, v6, v30
    v_fmac_f32 v5, v6, v6
    s_nop 1
    v_add_f32_dpp v5, v5, v5 row_ror:8 row_mask:0xf bank_mask:0xf
    s_nop 1
    v_add_f32_dpp v5, v5, v5 row_ror:4 row_mask:0xf bank_mask:0xf
    s_nop 1
    v_add_f32_dpp v5, v5, v5 row_ror:2 row_mask:0xf bank_mask:0xf
    s_nop 1
    v_add_f32_dpp v5, v5, v5 row_ror:1 row_mask:0xf bank_mask:0xf
    s_nop 0
    v_readlane_b32 s80, v5, 0
    v_readlane_b32 s81, v5, 16
    v_readlane_b32 s82, v5, 32
    v_readlane_b32 s83, v5, 48
    v_mov_b32 v5, s80
    v_add_f32 v5, s81, v5
    v_add_f32 v5, s82, v5
    v_add_f32 v5, s83, v5
    v_mul_f32 v5, s10, v5
    v_cvt_pk_bf16_f32 v6, v4, v5
    v_lshlrev_b32 v4, 16, v6
    v_and_b32 v5, 0xffff0000, v6
    v_add_f32 v5, 0x3727c5ac, v5
    v_cvt_pk_bf16_f32 v5, v5, v5
    v_lshlrev_b32 v5, 16, v5
    v_sqrt_f32 v5, v5
    s_nop 0
    v_cvt_pk_bf16_f32 v5, v5, v5
    v_lshlrev_b32 v5, 16, v5
    v_rcp_f32 v7, v5
    s_nop 0
    v_sub_f32 v8, v8, v4
    v_sub_f32 v9, v9, v4
    v_cvt_pk_bf16_f32 v6, v8, v9
    v_lshlrev_b32 v8, 16, v6
    v_and_b32 v9, 0xffff0000, v6
    v_mul_f32 v6, v8, v7
    v_fma_f32 v8, -v6, v5, v8
    v_fma_f32 v8, v8, v7, v6
    v_mul_f32 v6, v9, v7
    v_fma_f32 v9, -v6, v5, v9
    v_fma_f32 v9, v9, v7, v6
    v_cvt_pk_bf16_f32 v6, v8, v9
    v_lshlrev_b32 v8, 16, v6
    v_and_b32 v9, 0xffff0000, v6
    v_sub_f32 v10, v10, v4
    v_sub_f32 v11, v11, v4
    v_cvt_pk_bf16_f32 v6, v10, v11
    v_lshlrev_b32 v10, 16, v6
    v_and_b32 v11, 0xffff0000, v6
    v_mul_f32 v6, v10, v7
    v_fma_f32 v10, -v6, v5, v10
    v_fma_f32 v10, v10, v7, v6
    v_mul_f32 v6, v11, v7
    v_fma_f32 v11, -v6, v5, v11
    v_fma_f32 v11, v11, v7, v6
    v_cvt_pk_bf16_f32 v6, v10, v11
    v_lshlrev_b32 v10, 16, v6
    v_and_b32 v11, 0xffff0000, v6
    v_sub_f32 v12, v12, v4
    v_sub_f32 v13, v13, v4
    v_cvt_pk_bf16_f32 v6, v12, v13
    v_lshlrev_b32 v12, 16, v6
    v_and_b32 v13, 0xffff0000, v6
    v_mul_f32 v6, v12, v7
    v_fma_f32 v12, -v6, v5, v12
    v_fma_f32 v12, v12, v7, v6
    v_mul_f32 v6, v13, v7
    v_fma_f32 v13, -v6, v5, v13
    v_fma_f32 v13, v13, v7, v6
    v_cvt_pk_bf16_f32 v6, v12, v13
    v_lshlrev_b32 v12, 16, v6
    v_and_b32 v13, 0xffff0000, v6
    v_sub_f32 v14, v14, v4
    v_sub_f32 v15, v15, v4
    v_cvt_pk_bf16_f32 v6, v14, v15
    v_lshlrev_b32 v14, 16, v6
    v_and_b32 v15, 0xffff0000, v6
    v_mul_f32 v6, v14, v7
    v_fma_f32 v14, -v6, v5, v14
    v_fma_f32 v14, v14, v7, v6
    v_mul_f32 v6, v15, v7
    v_fma_f32 v15, -v6, v5, v15
    v_fma_f32 v15, v15, v7, v6
    v_cvt_pk_bf16_f32 v6, v14, v15
    v_lshlrev_b32 v14, 16, v6
    v_and_b32 v15, 0xffff0000, v6
    v_sub_f32 v16, v16, v4
    v_sub_f32 v17, v17, v4
    v_cvt_pk_bf16_f32 v6, v16, v17
    v_lshlrev_b32 v16, 16, v6
    v_and_b32 v17, 0xffff0000, v6
    v_mul_f32 v6, v16, v7
    v_fma_f32 v16, -v6, v5, v16
    v_fma_f32 v16, v16, v7, v6
    v_mul_f32 v6, v17, v7
    v_fma_f32 v17, -v6, v5, v17
    v_fma_f32 v17, v17, v7, v6
    v_cvt_pk_bf16_f32 v6, v16, v17
    v_lshlrev_b32 v16, 16, v6
    v_and_b32 v17, 0xffff0000, v6
    v_mul_f32 v16, v16, v30
    v_mul_f32 v17, v17, v30
    v_lshlrev_b32 v6, 5, v0
    v_lshlrev_b32 v7, 3, v0
    ds_write_b128 v6, v[8:11] offset:2816
    ds_write_b128 v6, v[12:15] offset:2832
    ds_write_b64 v7, v[16:17] offset:4864
    s_cmp_ge_u32 s2, 216
    s_cbranch_scc1 L_hh_noth1
    s_waitcnt vmcnt(0) lgkmcnt(0)
    v_and_b32 v3, 15, v0
    v_lshrrev_b32 v4, 4, v0
    s_mul_i32 s12, s8, 6144
    s_add_u32 s12, s12, 75776
    v_lshlrev_b32 v5, 7, v4
    v_lshl_add_u32 v5, v3, 3, v5
    v_add_u32 v5, s12, v5
    s_lshl_b32 s12, s73, 2
    v_lshl_add_u32 v6, v4, 2, s12
    ds_read_b64 v[32:33], v5 offset:0
    ds_read_b32 v56, v6 offset:2816
    ds_read_b64 v[34:35], v5 offset:512
    ds_read_b32 v57, v6 offset:2832
    ds_read_b64 v[36:37], v5 offset:1024
    ds_read_b32 v58, v6 offset:2848
    ds_read_b64 v[38:39], v5 offset:1536
    ds_read_b32 v59, v6 offset:2864
    ds_read_b64 v[40:41], v5 offset:2048
    ds_read_b32 v60, v6 offset:2880
    ds_read_b64 v[42:43], v5 offset:2560
    ds_read_b32 v61, v6 offset:2896
    ds_read_b64 v[44:45], v5 offset:3072
    ds_read_b32 v62, v6 offset:2912
    ds_read_b64 v[46:47], v5 offset:3584
    ds_read_b32 v63, v6 offset:2928
    ds_read_b64 v[48:49], v5 offset:4096
    ds_read_b32 v64, v6 offset:2944
    ds_read_b64 v[50:51], v5 offset:4608
    ds_read_b32 v65, v6 offset:2960
    ds_read_b64 v[52:53], v5 offset:5120
    ds_read_b32 v66, v6 offset:2976
    ds_read_b64 v[54:55], v5 offset:5632
    ds_read_b32 v67, v6 offset:2992
    v_mov_b32 v20, 0
    v_mov_b32 v21, 0
    v_mov_b32 v22, 0
    v_mov_b32 v23, 0
    s_waitcnt lgkmcnt(15)
    v_lshlrev_b32 v72, 16, v32
    v_and_b32 v73, 0xffff0000, v32
    v_lshlrev_b32 v74, 16, v33
    v_and_b32 v75, 0xffff0000, v33
    v_fmac_f32 v20, v56, v72
    v_fmac_f32 v21, v56, v73
    v_fmac_f32 v22, v56, v74
    v_fmac_f32 v23, v56, v75
    s_waitcnt lgkmcnt(15)
    v_lshlrev_b32 v72, 16, v34
    v_and_b32 v73, 0xffff0000, v34
    v_lshlrev_b32 v74, 16, v35
    v_and_b32 v75, 0xffff0000, v35
    v_fmac_f32 v20, v57, v72
    v_fmac_f32 v21, v57, v73
    v_fmac_f32 v22, v57, v74
    v_fmac_f32 v23, v57, v75
    s_waitcnt lgkmcnt(15)
    v_lshlrev_b32 v72, 16, v36
    v_and_b32 v73, 0xffff0000, v36
    v_lshlrev_b32 v74, 16, v37
    v_and_b32 v75, 0xffff0000, v37
    v_fmac_f32 v20, v58, v72
    v_fmac_f32 v21, v58, v73
    v_fmac_f32 v22, v58, v74
    v_fmac_f32 v23, v58, v75
    s_waitcnt lgkmcnt(15)
    v_lshlrev_b32 v72, 16, v38
    v_and_b32 v73, 0xffff0000, v38
    v_lshlrev_b32 v74, 16, v39
    v_and_b32 v75, 0xffff0000, v39
    v_fmac_f32 v20, v59, v72
    v_fmac_f32 v21, v59, v73
    v_fmac_f32 v22, v59, v74
    v_fmac_f32 v23, v59, v75
    s_waitcnt lgkmcnt(14)
    v_lshlrev_b32 v72, 16, v40
    v_and_b32 v73, 0xffff0000, v40
    v_lshlrev_b32 v74, 16, v41
    v_and_b32 v75, 0xffff0000, v41
    v_fmac_f32 v20, v60, v72
    v_fmac_f32 v21, v60, v73
    v_fmac_f32 v22, v60, v74
    v_fmac_f32 v23, v60, v75
    s_waitcnt lgkmcnt(12)
    v_lshlrev_b32 v72, 16, v42
    v_and_b32 v73, 0xffff0000, v42
    v_lshlrev_b32 v74, 16, v43
    v_and_b32 v75, 0xffff0000, v43
    v_fmac_f32 v20, v61, v72
    v_fmac_f32 v21, v61, v73
    v_fmac_f32 v22, v61, v74
    v_fmac_f32 v23, v61, v75
    s_waitcnt lgkmcnt(10)
    v_lshlrev_b32 v72, 16, v44
    v_and_b32 v73, 0xffff0000, v44
    v_lshlrev_b32 v74, 16, v45
    v_and_b32 v75, 0xffff0000, v45
    v_fmac_f32 v20, v62, v72
    v_fmac_f32 v21, v62, v73
    v_fmac_f32 v22, v62, v74
    v_fmac_f32 v23, v62, v75
    s_waitcnt lgkmcnt(8)
    v_lshlrev_b32 v72, 16, v46
    v_and_b32 v73, 0xffff0000, v46
    v_lshlrev_b32 v74, 16, v47
    v_and_b32 v75, 0xffff0000, v47
    v_fmac_f32 v20, v63, v72
    v_fmac_f32 v21, v63, v73
    v_fmac_f32 v22, v63, v74
    v_fmac_f32 v23, v63, v75
    s_waitcnt lgkmcnt(6)
    v_lshlrev_b32 v72, 16, v48
    v_and_b32 v73, 0xffff0000, v48
    v_lshlrev_b32 v74, 16, v49
    v_and_b32 v75, 0xffff0000, v49
    v_fmac_f32 v20, v64, v72
    v_fmac_f32 v21, v64, v73
    v_fmac_f32 v22, v64, v74
    v_fmac_f32 v23, v64, v75
    s_waitcnt lgkmcnt(4)
    v_lshlrev_b32 v72, 16, v50
    v_and_b32 v73, 0xffff0000, v50
    v_lshlrev_b32 v74, 16, v51
    v_and_b32 v75, 0xffff0000, v51
    v_fmac_f32 v20, v65, v72
    v_fmac_f32 v21, v65, v73
    v_fmac_f32 v22, v65, v74
    v_fmac_f32 v23, v65, v75
    s_waitcnt lgkmcnt(2)
    v_lshlrev_b32 v72, 16, v52
    v_and_b32 v73, 0xffff0000, v52
    v_lshlrev_b32 v74, 16, v53
    v_and_b32 v75, 0xffff0000, v53
    v_fmac_f32 v20, v66, v72
    v_fmac_f32 v21, v66, v73
    v_fmac_f32 v22, v66, v74
    v_fmac_f32 v23, v66, v75
    s_waitcnt lgkmcnt(0)
    v_lshlrev_b32 v72, 16, v54
    v_and_b32 v73, 0xffff0000, v54
    v_lshlrev_b32 v74, 16, v55
    v_and_b32 v75, 0xffff0000, v55
    v_fmac_f32 v20, v67, v72
    v_fmac_f32 v21, v67, v73
    v_fmac_f32 v22, v67, v74
    v_fmac_f32 v23, v67, v75
    s_lshl_b32 s12, s8, 10
    v_lshlrev_b32 v5, 8, v4
    v_lshl_add_u32 v5, v3, 4, v5
    v_add_u32 v5, s12, v5
    ds_write_b128 v5, v[20:23] offset:20480
    s_waitcnt lgkmcnt(0)
    v_mov_b32 v3, 16
    v_mov_b32 v4, 1
    s_mov_b64 exec, 1
    ds_add_u32 v3, v4
    s_mov_b64 exec, -1
    s_cmp_eq_u32 s8, 0
    s_cbranch_scc0 L_nos2_19
    s_mov_b32 s79, 0x40000
L_cw_20:
    v_mov_b32 v3, 16
    ds_read_b32 v3, v3
    s_waitcnt lgkmcnt(0)
    v_readfirstlane_b32 s78, v3
    s_cmp_ge_u32 s78, 4
    s_cbranch_scc1 L_cwd_21

    s_sub_u32 s79, s79, 1
    s_cmp_lg_u32 s79, 0
    s_cbranch_scc1 L_cw_20
L_cwd_21:
    v_and_b32 v3, 15, v0
    v_lshlrev_b32 v3, 4, v3
    v_lshrrev_b32 v4, 4, v0
    v_lshl_add_u32 v3, v4, 10, v3
    ds_read_b128 v[20:23], v3 offset:20480
    ds_read_b128 v[32:35], v3 offset:20736
    ds_read_b128 v[36:39], v3 offset:20992
    ds_read_b128 v[40:43], v3 offset:21248
    s_waitcnt lgkmcnt(0)
    v_add_f32 v20, v20, v32
    v_add_f32 v36, v36, v40
    v_add_f32 v21, v21, v33
    v_add_f32 v37, v37, v41
    v_add_f32 v22, v22, v34
    v_add_f32 v38, v38, v42
    v_add_f32 v23, v23, v35
    v_add_f32 v39, v39, v43
    v_add_f32 v20, v20, v36
    v_add_f32 v21, v21, v37
    v_add_f32 v22, v22, v38
    v_add_f32 v23, v23, v39
    v_mov_b32 v32, v20
    v_mov_b32 v33, v21
    v_mov_b32 v34, v22
    v_mov_b32 v35, v23
    s_nop 1
    v_permlane16_swap_b32 v20, v32
    v_permlane16_swap_b32 v21, v33
    v_permlane16_swap_b32 v22, v34
    v_permlane16_swap_b32 v23, v35
    v_add_f32 v20, v20, v32
    v_add_f32 v21, v21, v33
    v_add_f32 v22, v22, v34
    v_add_f32 v23, v23, v35
    v_mov_b32 v32, v20
    v_mov_b32 v33, v21
    v_mov_b32 v34, v22
    v_mov_b32 v35, v23
    s_nop 1
    v_permlane32_swap_b32 v20, v32
    v_permlane32_swap_b32 v21, v33
    v_permlane32_swap_b32 v22, v34
    v_permlane32_swap_b32 v23, v35
    v_add_f32 v20, v20, v32
    v_add_f32 v21, v21, v33
    v_add_f32 v22, v22, v34
    v_add_f32 v23, v23, v35
    v_and_or_b32 v20, v20, v1, s64
    v_and_or_b32 v21, v21, v1, s65
    v_and_or_b32 v22, v22, v1, s66
    v_and_or_b32 v23, v23, v1, s67
    s_mul_i32 s9, s2, 43691
    s_lshr_b32 s9, s9, 17
    s_mul_i32 s10, s9, 3
    s_sub_u32 s10, s2, s10
    s_mul_i32 s11, s10, 18432
    s_lshl_b32 s12, s9, 8
    s_add_u32 s11, s11, s12
    s_add_u32 s11, s11, 73728
    s_mov_b32 exec_lo, 0xffff
    s_mov_b32 exec_hi, 0x0
    buffer_store_dwordx4 v[20:23], v2, s[44:47], s11 offen sc1
    s_mov_b64 exec, -1
L_nos2_19:
L_hh_noth1:
    s_mov_b32 s56, s30
    s_and_b32 s57, s31, 0xffff
    s_mov_b32 s58, 9216
    s_mov_b32 s59, 0x00020000
    s_cmp_eq_u32 s8, 0
    s_cbranch_scc0 L_hh_nopoll
    s_mul_i32 s11, s6, 144
    s_add_u32 s11, s11, 73728
    v_lshrrev_b32 v4, 4, v0
    s_mov_b32 s14, 18432
    v_mul_lo_u32 v4, v4, s14
    v_and_b32 v5, 15, v0
    v_lshl_add_u32 v4, v5, 4, v4
    v_lshlrev_b32 v6, 3, v5
    s_mul_i32 s13, s6, 72
    v_mov_b32 v32, 0
    v_mov_b32 v33, 0
    v_mov_b32 v34, 0
    v_mov_b32 v35, 0
    s_mov_b32 exec_lo, 0x1ff
    s_mov_b32 exec_hi, 0x0
    buffer_load_dwordx2 v[44:45], v6, s[56:59], s13 offen
    s_mov_b32 exec_lo, 0x1ff01ff
    s_mov_b32 exec_hi, 0x1ff
    s_mov_b32 s79, 0x40000
L_hhpoll_22:
    buffer_load_dwordx4 v[32:35], v4, s[44:47], s11 offen sc1
    s_waitcnt vmcnt(0)
    v_xor_b32 v40, s64, v32
    v_xor_b32 v41, s65, v33
    v_xor_b32 v42, s66, v34
    v_or3_b32 v40, v40, v41, v42
    v_xor_b32 v41, s67, v35
    v_or_b32 v40, v40, v41
    v_and_b32 v40, 0xff, v40
    v_cmp_ne_u32 vcc, 0, v40
    s_nop 1
    s_cbranch_vccz L_hhdone_23
    s_sleep 4
    s_sub_u32 s79, s79, 1
    s_cmp_lg_u32 s79, 0
    s_cbranch_scc1 L_hhpoll_22
L_hhdone_23:
    s_mov_b64 exec, -1
    v_and_b32 v32, v1, v32
    v_and_b32 v33, v1, v33
    v_and_b32 v34, v1, v34
    v_and_b32 v35, v1, v35
    v_mov_b32 v36, v32
    v_mov_b32 v37, v33
    v_mov_b32 v38, v34
    v_mov_b32 v39, v35
    s_nop 1
    v_permlane16_swap_b32 v32, v36
    v_permlane16_swap_b32 v33, v37
    v_permlane16_swap_b32 v34, v38
    v_permlane16_swap_b32 v35, v39
    v_add_f32 v32, v32, v36
    v_add_f32 v33, v33, v37
    v_add_f32 v34, v34, v38
    v_add_f32 v35, v35, v39
    v_mov_b32 v36, v32
    v_mov_b32 v37, v33
    v_mov_b32 v38, v34
    v_mov_b32 v39, v35
    s_nop 1
    v_permlane32_swap_b32 v32, v36
    v_permlane32_swap_b32 v33, v37
    v_permlane32_swap_b32 v34, v38
    v_permlane32_swap_b32 v35, v39
    v_add_f32 v32, v32, v36
    v_add_f32 v33, v33, v37
    v_add_f32 v34, v34, v38
    v_add_f32 v35, v35, v39
    v_cvt_pk_bf16_f32 v40, v32, v33
    v_lshlrev_b32 v32, 16, v40
    v_and_b32 v33, 0xffff0000, v40
    v_cvt_pk_bf16_f32 v40, v34, v35
    v_lshlrev_b32 v34, 16, v40
    v_and_b32 v35, 0xffff0000, v40
    v_lshlrev_b32 v36, 16, v44
    v_and_b32 v37, 0xffff0000, v44
    v_lshlrev_b32 v38, 16, v45
    v_and_b32 v39, 0xffff0000, v45
    v_add_f32 v32, v32, v36
    v_add_f32 v33, v33, v37
    v_add_f32 v34, v34, v38
    v_add_f32 v35, v35, v39
    v_cvt_pk_bf16_f32 v40, v32, v33
    v_lshlrev_b32 v32, 16, v40
    v_and_b32 v33, 0xffff0000, v40
    v_cvt_pk_bf16_f32 v40, v34, v35
    v_lshlrev_b32 v34, 16, v40
    v_and_b32 v35, 0xffff0000, v40
    s_mov_b32 s12, 0x3d372713
    s_mov_b32 s13, 0x40135761
    v_mul_f32 v36, v32, v32
    v_mul_f32 v36, v36, v32
    v_fma_f32 v36, v36, s12, v32
    v_mul_f32 v36, s13, v36
    v_exp_f32 v36, v36
    s_nop 0
    v_add_f32 v36, 1.0, v36
    v_rcp_f32 v36, v36
    s_nop 0
    v_fma_f32 v32, -v36, v32, v32
    v_mul_f32 v37, v33, v33
    v_mul_f32 v37, v37, v33
    v_fma_f32 v37, v37, s12, v33
    v_mul_f32 v37, s13, v37
    v_exp_f32 v37, v37
    s_nop 0
    v_add_f32 v37, 1.0, v37
    v_rcp_f32 v37, v37
    s_nop 0
    v_fma_f32 v33, -v37, v33, v33
    v_mul_f32 v38, v34, v34
    v_mul_f32 v38, v38, v34
    v_fma_f32 v38, v38, s12, v34
    v_mul_f32 v38, s13, v38
    v_exp_f32 v38, v38
    s_nop 0
    v_add_f32 v38, 1.0, v38
    v_rcp_f32 v38, v38
    s_nop 0
    v_fma_f32 v34, -v38, v34, v34
    v_mul_f32 v39, v35, v35
    v_mul_f32 v39, v39, v35
    v_fma_f32 v39, v39, s12, v35
    v_mul_f32 v39, s13, v39
    v_exp_f32 v39, v39
    s_nop 0
    v_add_f32 v39, 1.0, v39
    v_rcp_f32 v39, v39
    s_nop 0
    v_fma_f32 v35, -v39, v35, v35
    v_cvt_pk_bf16_f32 v40, v32, v33
    v_lshlrev_b32 v32, 16, v40
    v_and_b32 v33, 0xffff0000, v40
    v_cvt_pk_bf16_f32 v40, v34, v35
    v_lshlrev_b32 v34, 16, v40
    v_and_b32 v35, 0xffff0000, v40
    v_lshlrev_b32 v5, 4, v5
    s_mov_b32 exec_lo, 0x1ff
    s_mov_b32 exec_hi, 0x0
    ds_write_b128 v5, v[32:35] offset:6144
    s_mov_b64 exec, -1
    s_waitcnt lgkmcnt(0)
    v_mov_b32 v3, 28
    v_mov_b32 v4, 1
    s_mov_b64 exec, 1
    ds_add_u32 v3, v4
    s_mov_b64 exec, -1
L_hh_nopoll:
    s_mov_b32 s79, 0x40000
L_cw_24:
    v_mov_b32 v3, 28
    ds_read_b32 v3, v3
    s_waitcnt lgkmcnt(0)
    v_readfirstlane_b32 s78, v3
    s_cmp_ge_u32 s78, 1
    s_cbranch_scc1 L_cwd_25
    s_sleep 6
    s_sub_u32 s79, s79, 1
    s_cmp_lg_u32 s79, 0
    s_cbranch_scc1 L_cw_24
L_cwd_25:
    s_mov_b32 s79, 0x40000
L_cw_26:
    v_mov_b32 v3, 36
    ds_read_b32 v3, v3
    s_waitcnt lgkmcnt(0)
    v_readfirstlane_b32 s78, v3
    s_cmp_ge_u32 s78, 8
    s_cbranch_scc1 L_cwd_27
    s_sleep 3
    s_sub_u32 s79, s79, 1
    s_cmp_lg_u32 s79, 0
    s_cbranch_scc1 L_cw_26
L_cwd_27:
    s_cmp_eq_u32 s8, 3
    s_cbranch_scc1 L_hh_nob
    s_mov_b32 s9, s8
    s_cmp_eq_u32 s9, 2
    s_cselect_b32 s12, s7, 0
    s_cmp_lg_u32 s12, 0
    s_cbranch_scc1 L_hh_nob
    s_cmp_eq_u32 s9, 2
    s_cselect_b32 s68, 0x00ff00ff, -1
    v_and_b32 v4, 7, v0
    v_lshrrev_b32 v5, 1, v4
    v_and_b32 v4, 1, v4
    v_mov_b32 v6, 0xffff
    v_mov_b32 v7, 0xffff0000
    v_cmp_eq_u32 vcc, 1, v4
    s_nop 1
    v_cndmask_b32 v6, v6, v7, vcc
    v_and_b32 v4, 8, v0
    v_cmp_eq_u32 vcc, 0, v4
    s_nop 1
    v_cndmask_b32 v6, 0, v6, vcc
    v_cmp_eq_u32 vcc, 0, v5
    s_nop 1
    v_cndmask_b32 v112, 0, v6, vcc
    v_cmp_eq_u32 vcc, 1, v5
    s_nop 1
    v_cndmask_b32 v113, 0, v6, vcc
    v_cmp_eq_u32 vcc, 2, v5
    s_nop 1
    v_cndmask_b32 v114, 0, v6, vcc
    v_cmp_eq_u32 vcc, 3, v5
    s_nop 1
    v_cndmask_b32 v115, 0, v6, vcc
    s_mul_i32 s11, s6, 36
    s_mul_i32 s11, s11, 1152
    s_add_u32 s11, s11, s72
    s_lshl_b32 s12, s9, 8
    s_add_u32 s11, s11, s12
    v_lshrrev_b32 v4, 4, v0
    v_mul_u32_u24 v4, 1152, v4
    v_and_b32 v5, 15, v0
    v_lshl_add_u32 v4, v5, 4, v4
    s_mov_b32 exec_lo, s68
    s_mov_b32 exec_hi, s68
    buffer_load_dwordx4 v[32:35], v4, s[52:55], s11 offen nt
    s_add_u32 s11, s11, 4608
    buffer_load_dwordx4 v[36:39], v4, s[52:55], s11 offen nt
    s_add_u32 s11, s11, 4608
    buffer_load_dwordx4 v[40:43], v4, s[52:55], s11 offen nt
    s_add_u32 s11, s11, 4608
    s_waitcnt vmcnt(2)
    buffer_load_dwordx4 v[44:47], v4, s[52:55], s11 offen nt
    s_add_u32 s11, s11, 4608
    s_waitcnt vmcnt(2)
    buffer_load_dwordx4 v[48:51], v4, s[52:55], s11 offen nt
    s_add_u32 s11, s11, 4608
    s_waitcnt vmcnt(2)
    buffer_load_dwordx4 v[52:55], v4, s[52:55], s11 offen nt
    s_add_u32 s11, s11, 4608
    s_waitcnt vmcnt(2)
    buffer_load_dwordx4 v[56:59], v4, s[52:55], s11 offen nt
    s_add_u32 s11, s11, 4608
    s_waitcnt vmcnt(2)
    buffer_load_dwordx4 v[60:63], v4, s[52:55], s11 offen nt
    s_add_u32 s11, s11, 4608
    s_waitcnt vmcnt(2)
    buffer_load_dwordx4 v[64:67], v4, s[52:55], s11 offen nt
    s_add_u32 s11, s11, 4608
    s_mov_b64 exec, -1
    v_lshrrev_b32 v3, 4, v0
    v_lshlrev_b32 v3, 2, v3
    ds_read_b32 v72, v3 offset:6144
    ds_read_b32 v73, v3 offset:6160
    ds_read_b32 v74, v3 offset:6176
    ds_read_b32 v75, v3 offset:6192
    ds_read_b32 v76, v3 offset:6208
    ds_read_b32 v77, v3 offset:6224
    ds_read_b32 v78, v3 offset:6240
    ds_read_b32 v79, v3 offset:6256
    ds_read_b32 v80, v3 offset:6272
    v_mov_b32 v8, 0
    v_mov_b32 v9, 0
    v_mov_b32 v10, 0
    v_mov_b32 v11, 0
    s_waitcnt vmcnt(0) lgkmcnt(0)
    v_cvt_pk_bf16_f32 v72, v72, v72
    v_and_b32 v16, v72, v112
    v_and_b32 v17, v72, v113
    v_and_b32 v18, v72, v114
    v_and_b32 v19, v72, v115
    s_nop 1
    v_mfma_f32_16x16x32_bf16 v[8:11], v[16:19], v[32:35], v[8:11]
    v_cvt_pk_bf16_f32 v73, v73, v73
    v_and_b32 v20, v73, v112
    v_and_b32 v21, v73, v113
    v_and_b32 v22, v73, v114
    v_and_b32 v23, v73, v115
    s_nop 1
    v_mfma_f32_16x16x32_bf16 v[8:11], v[20:23], v[36:39], v[8:11]
    v_cvt_pk_bf16_f32 v74, v74, v74
    v_and_b32 v24, v74, v112
    v_and_b32 v25, v74, v113
    v_and_b32 v26, v74, v114
    v_and_b32 v27, v74, v115
    s_nop 1
    v_mfma_f32_16x16x32_bf16 v[8:11], v[24:27], v[40:43], v[8:11]
    v_cvt_pk_bf16_f32 v75, v75, v75
    v_and_b32 v16, v75, v112
    v_and_b32 v17, v75, v113
    v_and_b32 v18, v75, v114
    v_and_b32 v19, v75, v115
    s_nop 1
    v_mfma_f32_16x16x32_bf16 v[8:11], v[16:19], v[44:47], v[8:11]
    v_cvt_pk_bf16_f32 v76, v76, v76
    v_and_b32 v20, v76, v112
    v_and_b32 v21, v76, v113
    v_and_b32 v22, v76, v114
    v_and_b32 v23, v76, v115
    s_nop 1
    v_mfma_f32_16x16x32_bf16 v[8:11], v[20:23], v[48:51], v[8:11]
    v_cvt_pk_bf16_f32 v77, v77, v77
    v_and_b32 v24, v77, v112
    v_and_b32 v25, v77, v113
    v_and_b32 v26, v77, v114
    v_and_b32 v27, v77, v115
    s_nop 1
    v_mfma_f32_16x16x32_bf16 v[8:11], v[24:27], v[52:55], v[8:11]
    v_cvt_pk_bf16_f32 v78, v78, v78
    v_and_b32 v16, v78, v112
    v_and_b32 v17, v78, v113
    v_and_b32 v18, v78, v114
    v_and_b32 v19, v78, v115
    s_nop 1
    v_mfma_f32_16x16x32_bf16 v[8:11], v[16:19], v[56:59], v[8:11]
    v_cvt_pk_bf16_f32 v79, v79, v79
    v_and_b32 v20, v79, v112
    v_and_b32 v21, v79, v113
    v_and_b32 v22, v79, v114
    v_and_b32 v23, v79, v115
    s_nop 1
    v_mfma_f32_16x16x32_bf16 v[8:11], v[20:23], v[60:63], v[8:11]
    v_cvt_pk_bf16_f32 v80, v80, v80
    v_and_b32 v24, v80, v112
    v_and_b32 v25, v80, v113
    v_and_b32 v26, v80, v114
    v_and_b32 v27, v80, v115
    s_nop 1
    v_mfma_f32_16x16x32_bf16 v[8:11], v[24:27], v[64:67], v[8:11]
    v_and_b32 v4, 15, v0
    v_lshlrev_b32 v4, 5, v4
    v_lshrrev_b32 v5, 4, v0
    v_lshl_add_u32 v4, v5, 4, v4
    s_mul_i32 s11, s6, 2304
    s_lshl_b32 s12, s72, 1
    s_add_u32 s11, s11, s12
    s_lshl_b32 s12, s9, 9
    s_add_u32 s11, s11, s12
    s_add_u32 s11, s11, 720896
    s_nop 3
    v_and_or_b32 v8, v8, v1, s64
    v_and_or_b32 v9, v9, v1, s65
    v_and_or_b32 v10, v10, v1, s66
    v_and_or_b32 v11, v11, v1, s67
    s_mov_b32 exec_lo, s68
    s_mov_b32 exec_hi, 0
    buffer_store_dwordx4 v[8:11], v4, s[44:47], s11 offen sc1
    s_mov_b64 exec, -1
L_hh_nob:
    s_cmp_lt_u32 s2, 238
    s_cbranch_scc1 L_done
    s_sub_u32 s9, s2, 238
    v_lshrrev_b32 v3, 3, v0
    s_mov_b32 s14, 2304
    v_mul_lo_u32 v3, v3, s14
    v_and_b32 v4, 7, v0
    v_lshl_add_u32 v3, v4, 4, v3
    s_mul_i32 s11, s8, 73728
    s_lshl_b32 s12, s9, 7
    s_add_u32 s11, s11, s12
    s_add_u32 s11, s11, 720896
    s_add_u32 s12, s11, 18432
    s_add_u32 s13, s11, 36864
    s_add_u32 s14, s11, 55296
    s_mov_b32 s79, 0x40000
L_bpoll_28:
    buffer_load_dwordx4 v[8:11], v3, s[44:47], s11 offen sc1
    buffer_load_dwordx4 v[12:15], v3, s[44:47], s12 offen sc1
    buffer_load_dwordx4 v[16:19], v3, s[44:47], s13 offen sc1
    buffer_load_dwordx4 v[20:23], v3, s[44:47], s14 offen sc1
    s_waitcnt vmcnt(0)
    v_xor_b32 v32, s64, v8
    v_xor_b32 v33, s65, v9
    v_xor_b32 v34, s66, v10
    v_or3_b32 v32, v32, v33, v34
    v_xor_b32 v33, s67, v11
    v_or_b32 v32, v32, v33
    v_xor_b32 v33, s64, v12
    v_xor_b32 v34, s65, v13
    v_or3_b32 v32, v32, v33, v34
    v_xor_b32 v33, s66, v14
    v_xor_b32 v34, s67, v15
    v_or3_b32 v32, v32, v33, v34
    v_xor_b32 v33, s64, v16
    v_xor_b32 v34, s65, v17
    v_or3_b32 v32, v32, v33, v34
    v_xor_b32 v33, s66, v18
    v_xor_b32 v34, s67, v19
    v_or3_b32 v32, v32, v33, v34
    v_xor_b32 v33, s64, v20
    v_xor_b32 v34, s65, v21
    v_or3_b32 v32, v32, v33, v34
    v_xor_b32 v33, s66, v22
    v_xor_b32 v34, s67, v23
    v_or3_b32 v32, v32, v33, v34
    v_and_b32 v32, 0xff, v32
    v_cmp_ne_u32 vcc, 0, v32
    s_nop 1
    s_cbranch_vccz L_bdone_29
    s_sleep 2
    s_sub_u32 s79, s79, 1
    s_cmp_lg_u32 s79, 0
    s_cbranch_scc1 L_bpoll_28
L_bdone_29:
    v_and_b32 v8, v1, v8
    v_and_b32 v9, v1, v9
    v_and_b32 v10, v1, v10
    v_and_b32 v11, v1, v11
    v_and_b32 v12, v1, v12
    v_and_b32 v13, v1, v13
    v_and_b32 v14, v1, v14
    v_and_b32 v15, v1, v15
    v_and_b32 v16, v1, v16
    v_and_b32 v17, v1, v17
    v_and_b32 v18, v1, v18
    v_and_b32 v19, v1, v19
    v_and_b32 v20, v1, v20
    v_and_b32 v21, v1, v21
    v_and_b32 v22, v1, v22
    v_and_b32 v23, v1, v23
    v_add_f32 v8, v8, v12
    v_add_f32 v16, v16, v20
    v_add_f32 v9, v9, v13
    v_add_f32 v17, v17, v21
    v_add_f32 v10, v10, v14
    v_add_f32 v18, v18, v22
    v_add_f32 v11, v11, v15
    v_add_f32 v19, v19, v23
    v_add_f32 v8, v8, v16
    v_add_f32 v9, v9, v17
    v_add_f32 v10, v10, v18
    v_add_f32 v11, v11, v19
    s_nop 1
    v_permlane32_swap_b32 v8, v9
    v_permlane32_swap_b32 v10, v11
    v_add_f32 v8, v8, v9
    v_add_f32 v10, v10, v11
    s_nop 1
    v_permlane16_swap_b32 v8, v10
    v_add_f32 v8, v8, v10
    s_nop 1
    v_add_f32_dpp v8, v8, v8 row_ror:8 row_mask:0xf bank_mask:0xf
    v_lshrrev_b32 v5, 4, v0
    v_and_b32 v6, 1, v5
    v_lshrrev_b32 v5, 1, v5
    v_lshl_add_u32 v5, v6, 1, v5
    v_lshl_add_u32 v5, v4, 2, v5
    v_lshlrev_b32 v5, 2, v5
    s_lshl_b32 s14, s8, 7
    v_add_u32 v5, s14, v5
    s_mov_b32 s14, 0x00ff00ff
    s_mov_b32 s15, 0x00ff00ff
    s_mov_b64 exec, s[14:15]
    ds_write_b32 v5, v8 offset:55296
    s_mov_b64 exec, -1
    s_waitcnt lgkmcnt(0)
    v_mov_b32 v3, 56
    v_mov_b32 v4, 1
    s_mov_b64 exec, 1
    ds_add_u32 v3, v4
    s_mov_b64 exec, -1
    s_branch L_done
L_stream:
    s_mov_b32 s48, s18
    s_and_b32 s49, s19, 0xffff
    s_mov_b32 s50, 268435456
    s_mov_b32 s51, 0x00020000
    s_mov_b32 s52, s20
    s_and_b32 s53, s21, 0xffff
    s_mov_b32 s54, 268435456
    s_mov_b32 s55, 0x00020000
    s_sub_u32 s15, s3, 8
    s_lshl_b32 s8, s4, 24
    s_lshl_b32 s9, s5, 16
    s_add_u32 s8, s8, s9
    s_add_u32 s8, s8, 0xF00000
    s_lshl_b32 s9, s15, 10
    s_add_u32 s8, s8, s9
    s_add_u32 s9, s8, 4096
    s_add_u32 s9, s8, 0
    buffer_load_dwordx4 v[8:11], v2, s[48:51], s9 offen nt
    s_waitcnt lgkmcnt(0)
    s_barrier
    s_add_u32 s9, s8, 8192
    buffer_load_dwordx4 v[12:15], v2, s[48:51], s9 offen nt
    s_add_u32 s9, s8, 16384
    buffer_load_dwordx4 v[16:19], v2, s[48:51], s9 offen nt
    s_add_u32 s9, s8, 24576
    buffer_load_dwordx4 v[20:23], v2, s[48:51], s9 offen nt
    s_add_u32 s42, s42, 1
    s_and_b32 s64, s42, 0xff
    s_bfe_u32 s65, s42, 0x80008
    s_bfe_u32 s66, s42, 0x80010
    s_lshr_b32 s67, s42, 24
    s_add_u32 s65, s65, s64
    s_add_u32 s66, s66, s64
    s_add_u32 s67, s67, s64
    s_and_b32 s65, s65, 0xff
    s_and_b32 s66, s66, 0xff
    s_and_b32 s67, s67, 0xff
    s_mov_b32 s77, 0
    s_waitcnt vmcnt(3)
    s_add_u32 s9, s8, 32768
    buffer_load_dwordx4 v[24:27], v2, s[48:51], s9 offen nt
    s_waitcnt vmcnt(3)
    s_add_u32 s9, s8, 40960
    buffer_load_dwordx4 v[28:31], v2, s[48:51], s9 offen nt
    s_waitcnt vmcnt(3)
    s_add_u32 s9, s8, 49152
    buffer_load_dwordx4 v[32:35], v2, s[48:51], s9 offen nt
    s_waitcnt vmcnt(3)
    s_add_u32 s9, s8, 57344
    buffer_load_dwordx4 v[36:39], v2, s[48:51], s9 offen nt
    s_waitcnt lgkmcnt(0)
    v_mov_b32 v3, 40
    v_mov_b32 v4, 1
    s_mov_b64 exec, 1
    ds_add_u32 v3, v4
    s_mov_b64 exec, -1
    s_waitcnt vmcnt(5)
    s_add_u32 s9, s8, 0
    buffer_load_dwordx4 v[40:43], v2, s[52:55], s9 offen nt
    s_waitcnt vmcnt(5)
    s_add_u32 s9, s8, 8192
    buffer_load_dwordx4 v[44:47], v2, s[52:55], s9 offen nt
    s_waitcnt vmcnt(5)
    s_add_u32 s9, s8, 16384
    buffer_load_dwordx4 v[48:51], v2, s[52:55], s9 offen nt
    s_waitcnt vmcnt(5)
    s_add_u32 s9, s8, 24576
    buffer_load_dwordx4 v[52:55], v2, s[52:55], s9 offen nt
    s_waitcnt vmcnt(5)
    s_add_u32 s9, s8, 32768
    buffer_load_dwordx4 v[56:59], v2, s[52:55], s9 offen nt
    s_waitcnt lgkmcnt(0)
    v_mov_b32 v3, 36
    v_mov_b32 v4, 1
    s_mov_b64 exec, 1
    ds_add_u32 v3, v4
    s_mov_b64 exec, -1
    s_waitcnt vmcnt(5)
    s_add_u32 s9, s8, 40960
    buffer_load_dwordx4 v[60:63], v2, s[52:55], s9 offen nt
    s_cmp_lg_u32 s77, 0
    s_cbranch_scc1 L_sk_30
    v_mov_b32 v3, 4
    ds_read_b32 v3, v3
    s_waitcnt lgkmcnt(0)
    v_readfirstlane_b32 s78, v3
    s_cmp_ge_u32 s78, 4
    s_cbranch_scc0 L_sk_30
    s_call_b64 s[74:75], L_scores
L_sk_30:
    s_waitcnt vmcnt(5)
    s_add_u32 s9, s8, 49152
    buffer_load_dwordx4 v[64:67], v2, s[52:55], s9 offen nt
    s_cmp_lg_u32 s77, 0
    s_cbranch_scc1 L_sk_31
    v_mov_b32 v3, 4
    ds_read_b32 v3, v3
    s_waitcnt lgkmcnt(0)
    v_readfirstlane_b32 s78, v3
    s_cmp_ge_u32 s78, 4
    s_cbranch_scc0 L_sk_31
    s_call_b64 s[74:75], L_scores
L_sk_31:
    s_waitcnt vmcnt(5)
    s_add_u32 s9, s8, 57344
    buffer_load_dwordx4 v[68:71], v2, s[52:55], s9 offen nt
    s_cmp_lg_u32 s77, 0
    s_cbranch_scc1 L_s_scored
    s_mov_b32 s79, 0x40000
L_cw_32:
    v_mov_b32 v3, 4
    ds_read_b32 v3, v3
    s_waitcnt lgkmcnt(0)
    v_readfirstlane_b32 s78, v3
    s_cmp_ge_u32 s78, 4
    s_cbranch_scc1 L_cwd_33
    s_sleep 1
    s_sub_u32 s79, s79, 1
    s_cmp_lg_u32 s79, 0
    s_cbranch_scc1 L_cw_32
L_cwd_33:
    s_call_b64 s[74:75], L_scores
L_s_scored:
    v_mov_b32 v96, 0
    v_mov_b32 v97, 0
    v_mov_b32 v98, 0
    v_mov_b32 v99, 0
    v_lshrrev_b32 v3, 5, v0
    v_lshlrev_b32 v3, 9, v3
    v_and_b32 v4, 15, v0
    v_lshl_add_u32 v3, v4, 5, v3
    v_and_b32 v4, 16, v0
    v_add_u32 v3, v3, v4
    s_lshl_b32 s11, s15, 10
    v_add_u32 v118, s11, v3
    s_waitcnt vmcnt(7)
    v_mfma_f32_16x16x32_bf16 v[96:99], v[8:11], v[40:43], v[96:99]
    s_waitcnt vmcnt(6)
    v_mfma_f32_16x16x32_bf16 v[96:99], v[12:15], v[44:47], v[96:99]
    s_waitcnt vmcnt(5)
    v_mfma_f32_16x16x32_bf16 v[96:99], v[16:19], v[48:51], v[96:99]
    s_waitcnt vmcnt(4)
    v_mfma_f32_16x16x32_bf16 v[96:99], v[20:23], v[52:55], v[96:99]
    s_waitcnt vmcnt(3)
    v_mfma_f32_16x16x32_bf16 v[96:99], v[24:27], v[56:59], v[96:99]
    s_waitcnt vmcnt(2)
    v_mfma_f32_16x16x32_bf16 v[96:99], v[28:31], v[60:63], v[96:99]
    s_waitcnt vmcnt(1)
    v_mfma_f32_16x16x32_bf16 v[96:99], v[32:35], v[64:67], v[96:99]
    s_waitcnt vmcnt(0)
    v_mfma_f32_16x16x32_bf16 v[96:99], v[36:39], v[68:71], v[96:99]
    s_nop 7
    s_nop 1
    ds_write_b128 v118, v[96:99] offset:8192
    s_waitcnt lgkmcnt(0)
    v_mov_b32 v3, 20
    v_mov_b32 v4, 1
    s_mov_b64 exec, 1
    ds_add_u32 v3, v4
    s_mov_b64 exec, -1
    s_cmp_lg_u32 s15, 0
    s_cbranch_scc1 L_s_w0skip
    s_mov_b32 s79, 0x40000
L_cw_34:
    v_mov_b32 v3, 20
    ds_read_b32 v3, v3
    s_waitcnt lgkmcnt(0)
    v_readfirstlane_b32 s78, v3
    s_cmp_ge_u32 s78, 8
    s_cbranch_scc1 L_cwd_35

    s_sub_u32 s79, s79, 1
    s_cmp_lg_u32 s79, 0
    s_cbranch_scc1 L_cw_34
L_cwd_35:
    ds_read_b128 v[8:11], v2 offset:8192
    ds_read_b128 v[12:15], v2 offset:9216
    ds_read_b128 v[16:19], v2 offset:10240
    ds_read_b128 v[20:23], v2 offset:11264
    ds_read_b128 v[24:27], v2 offset:12288
    ds_read_b128 v[28:31], v2 offset:13312
    ds_read_b128 v[32:35], v2 offset:14336
    ds_read_b128 v[36:39], v2 offset:15360
    v_lshrrev_b32 v5, 3, v0
    v_lshlrev_b32 v5, 11, v5
    v_and_b32 v6, 7, v0
    v_lshl_add_u32 v5, v6, 4, v5
    s_lshl_b32 s12, s4, 14
    s_lshl_b32 s13, s5, 7
    s_add_u32 s12, s12, s13
    s_add_u32 s12, s12, 131072
    s_waitcnt lgkmcnt(0)
    v_add_f32 v8, v8, v12
    v_add_f32 v16, v16, v20
    v_add_f32 v24, v24, v28
    v_add_f32 v32, v32, v36
    v_add_f32 v9, v9, v13
    v_add_f32 v17, v17, v21
    v_add_f32 v25, v25, v29
    v_add_f32 v33, v33, v37
    v_add_f32 v10, v10, v14
    v_add_f32 v18, v18, v22
    v_add_f32 v26, v26, v30
    v_add_f32 v34, v34, v38
    v_add_f32 v11, v11, v15
    v_add_f32 v19, v19, v23
    v_add_f32 v27, v27, v31
    v_add_f32 v35, v35, v39
    v_add_f32 v8, v8, v16
    v_add_f32 v24, v24, v32
    v_add_f32 v9, v9, v17
    v_add_f32 v25, v25, v33
    v_add_f32 v10, v10, v18
    v_add_f32 v26, v26, v34
    v_add_f32 v11, v11, v19
    v_add_f32 v27, v27, v35
    v_add_f32 v8, v8, v24
    v_add_f32 v9, v9, v25
    v_add_f32 v10, v10, v26
    v_add_f32 v11, v11, v27
    v_and_or_b32 v8, v8, v1, s64
    v_and_or_b32 v9, v9, v1, s65
    v_and_or_b32 v10, v10, v1, s66
    v_and_or_b32 v11, v11, v1, s67
    buffer_store_dwordx4 v[8:11], v5, s[44:47], s12 offen sc1
L_s_w0skip:
    s_cmp_lt_u32 s2, 238
    s_cbranch_scc1 L_done
    s_sub_u32 s8, s2, 238
    v_lshrrev_b32 v3, 3, v0
    s_mov_b32 s14, 2304
    v_mul_lo_u32 v3, v3, s14
    v_and_b32 v4, 7, v0
    v_lshl_add_u32 v3, v4, 4, v3
    s_mul_i32 s11, s15, 36864
    s_lshl_b32 s12, s8, 7
    s_add_u32 s11, s11, s12
    s_add_u32 s11, s11, 409600
    s_add_u32 s12, s11, 18432
    s_mov_b32 s48, s16
    s_and_b32 s49, s17, 0xffff
    s_mov_b32 s50, 1152
    s_mov_b32 s51, 0x00020000
    s_mov_b32 s52, s34
    s_and_b32 s53, s35, 0xffff
    s_mov_b32 s54, 1152
    s_mov_b32 s55, 0x00020000
    s_mov_b32 s56, s36
    s_and_b32 s57, s37, 0xffff
    s_mov_b32 s58, 1152
    s_mov_b32 s59, 0x00020000
    s_lshl_b32 s13, s8, 6
    v_lshlrev_b32 v6, 1, v0
    buffer_load_ushort v40, v6, s[48:51], s13 offen
    buffer_load_ushort v41, v6, s[52:55], s13 offen
    v_lshrrev_b32 v5, 4, v0
    v_and_b32 v6, 1, v5
    v_lshrrev_b32 v5, 1, v5
    v_lshl_add_u32 v5, v6, 1, v5
    v_lshl_add_u32 v5, v4, 2, v5
    v_lshlrev_b32 v5, 2, v5
    s_lshl_b32 s14, s15, 7
    v_add_u32 v5, s14, v5
    s_mov_b32 s79, 0x40000
L_h3poll_36:
    buffer_load_dwordx4 v[8:11], v3, s[44:47], s11 offen sc1
    buffer_load_dwordx4 v[12:15], v3, s[44:47], s12 offen sc1
    s_waitcnt vmcnt(0)
    v_xor_b32 v16, s64, v8
    v_xor_b32 v17, s65, v9
    v_xor_b32 v18, s66, v10
    v_or3_b32 v16, v16, v17, v18
    v_xor_b32 v17, s67, v11
    v_or_b32 v16, v16, v17
    v_xor_b32 v17, s64, v12
    v_xor_b32 v18, s65, v13
    v_or3_b32 v16, v16, v17, v18
    v_xor_b32 v17, s66, v14
    v_xor_b32 v18, s67, v15
    v_or3_b32 v16, v16, v17, v18
    v_and_b32 v16, 0xff, v16
    v_cmp_ne_u32 vcc, 0, v16
    s_nop 1
    s_cbranch_vccz L_h3done_37

    s_sub_u32 s79, s79, 1
    s_cmp_lg_u32 s79, 0
    s_cbranch_scc1 L_h3poll_36
L_h3done_37:
    v_and_b32 v8, v1, v8
    v_and_b32 v9, v1, v9
    v_and_b32 v10, v1, v10
    v_and_b32 v11, v1, v11
    v_and_b32 v12, v1, v12
    v_and_b32 v13, v1, v13
    v_and_b32 v14, v1, v14
    v_and_b32 v15, v1, v15
    v_add_f32 v8, v8, v12
    v_add_f32 v9, v9, v13
    v_add_f32 v10, v10, v14
    v_add_f32 v11, v11, v15
    s_nop 1
    v_permlane32_swap_b32 v8, v9
    v_permlane32_swap_b32 v10, v11
    v_add_f32 v8, v8, v9
    v_add_f32 v10, v10, v11
    s_nop 1
    v_permlane16_swap_b32 v8, v10
    v_add_f32 v8, v8, v10
    s_nop 1
    v_add_f32_dpp v8, v8, v8 row_ror:8 row_mask:0xf bank_mask:0xf
    s_mov_b32 s10, 0x00ff00ff
    s_mov_b32 s11, 0x00ff00ff
    s_mov_b64 exec, s[10:11]
    ds_write_b32 v5, v8 offset:53248
    s_mov_b64 exec, -1
    s_waitcnt lgkmcnt(0)
    v_mov_b32 v3, 52
    v_mov_b32 v4, 1
    s_mov_b64 exec, 1
    ds_add_u32 v3, v4
    s_mov_b64 exec, -1
    s_cmp_lg_u32 s15, 0
    s_cbranch_scc1 L_done
    s_mov_b32 s79, 0x40000
L_cw_38:
    v_mov_b32 v3, 56
    ds_read_b32 v3, v3
    s_waitcnt lgkmcnt(0)
    v_readfirstlane_b32 s78, v3
    s_cmp_ge_u32 s78, 4
    s_cbranch_scc1 L_cwd_39

    s_sub_u32 s79, s79, 1
    s_cmp_lg_u32 s79, 0
    s_cbranch_scc1 L_cw_38
L_cwd_39:
    s_mov_b32 s79, 0x40000
L_cw_40:
    v_mov_b32 v3, 52
    ds_read_b32 v3, v3
    s_waitcnt lgkmcnt(0)
    v_readfirstlane_b32 s78, v3
    s_cmp_ge_u32 s78, 8
    s_cbranch_scc1 L_cwd_41

    s_sub_u32 s79, s79, 1
    s_cmp_lg_u32 s79, 0
    s_cbranch_scc1 L_cw_40
L_cwd_41:
    v_lshlrev_b32 v3, 2, v0
    v_and_b32 v3, 0x7f, v3
    ds_read_b32 v8, v3 offset:53248
    ds_read_b32 v9, v3 offset:53376
    ds_read_b32 v10, v3 offset:53504
    ds_read_b32 v11, v3 offset:53632
    ds_read_b32 v12, v3 offset:53760
    ds_read_b32 v13, v3 offset:53888
    ds_read_b32 v14, v3 offset:54016
    ds_read_b32 v15, v3 offset:54144
    ds_read_b32 v24, v3 offset:55296
    ds_read_b32 v25, v3 offset:55424
    ds_read_b32 v26, v3 offset:55552
    ds_read_b32 v27, v3 offset:55680
    s_waitcnt lgkmcnt(0)
    v_add_f32 v8, v8, v12
    v_add_f32 v9, v9, v13
    v_add_f32 v10, v10, v14
    v_add_f32 v11, v11, v15
    v_add_f32 v24, v24, v25
    v_add_f32 v26, v26, v27
    v_add_f32 v8, v8, v10
    v_add_f32 v9, v9, v11
    v_add_f32 v24, v24, v26
    v_add_f32 v8, v8, v9
    v_cvt_pk_bf16_f32 v4, v8, v24
    v_lshlrev_b32 v8, 16, v4
    v_and_b32 v24, 0xffff0000, v4
    v_lshlrev_b32 v40, 16, v40
    v_lshlrev_b32 v41, 16, v41
    v_add_f32 v8, v40, v8
    v_add_f32 v24, v24, v41
    v_cvt_pk_bf16_f32 v4, v8, v24
    v_lshlrev_b32 v8, 16, v4
    v_and_b32 v24, 0xffff0000, v4
    v_add_f32 v8, v8, v24
    v_cvt_pk_bf16_f32 v8, v8, v8
    v_lshlrev_b32 v6, 1, v0
    s_mov_b32 exec_lo, 0xffffffff
    s_mov_b32 exec_hi, 0x0
    buffer_store_short v8, v6, s[56:59], s13 offen
    s_mov_b64 exec, -1
    s_cmp_lg_u32 s8, 0
    s_cbranch_scc1 L_done
    v_mov_b32 v32, s42
    v_mov_b32 v34, 0
    s_mov_b64 exec, 1
    buffer_store_dword v32, v34, s[44:47], 0 offen
    s_mov_b64 exec, -1
L_done:
    s_branch L_end
L_scores:
    v_and_b32 v3, 15, v0
    v_lshlrev_b32 v3, 4, v3
    ds_read_b128 v[72:75], v3 offset:5376
    ds_read_b128 v[76:79], v3 offset:5632
    s_waitcnt lgkmcnt(0)
    v_dot2_f32_bf16 v80, v8, v72, 0
    v_dot2_f32_bf16 v88, v8, v76, 0
    v_dot2_f32_bf16 v80, v9, v73, v80
    v_dot2_f32_bf16 v88, v9, v77, v88
    v_dot2_f32_bf16 v80, v10, v74, v80
    v_dot2_f32_bf16 v88, v10, v78, v88
    v_dot2_f32_bf16 v80, v11, v75, v80
    v_dot2_f32_bf16 v88, v11, v79, v88
    v_dot2_f32_bf16 v81, v12, v72, 0
    v_dot2_f32_bf16 v89, v12, v76, 0
    v_dot2_f32_bf16 v81, v13, v73, v81
    v_dot2_f32_bf16 v89, v13, v77, v89
    v_dot2_f32_bf16 v81, v14, v74, v81
    v_dot2_f32_bf16 v89, v14, v78, v89
    v_dot2_f32_bf16 v81, v15, v75, v81
    v_dot2_f32_bf16 v89, v15, v79, v89
    v_dot2_f32_bf16 v82, v16, v72, 0
    v_dot2_f32_bf16 v90, v16, v76, 0
    v_dot2_f32_bf16 v82, v17, v73, v82
    v_dot2_f32_bf16 v90, v17, v77, v90
    v_dot2_f32_bf16 v82, v18, v74, v82
    v_dot2_f32_bf16 v90, v18, v78, v90
    v_dot2_f32_bf16 v82, v19, v75, v82
    v_dot2_f32_bf16 v90, v19, v79, v90
    v_dot2_f32_bf16 v83, v20, v72, 0
    v_dot2_f32_bf16 v91, v20, v76, 0
    v_dot2_f32_bf16 v83, v21, v73, v83
    v_dot2_f32_bf16 v91, v21, v77, v91
    v_dot2_f32_bf16 v83, v22, v74, v83
    v_dot2_f32_bf16 v91, v22, v78, v91
    v_dot2_f32_bf16 v83, v23, v75, v83
    v_dot2_f32_bf16 v91, v23, v79, v91
    v_dot2_f32_bf16 v84, v24, v72, 0
    v_dot2_f32_bf16 v92, v24, v76, 0
    v_dot2_f32_bf16 v84, v25, v73, v84
    v_dot2_f32_bf16 v92, v25, v77, v92
    v_dot2_f32_bf16 v84, v26, v74, v84
    v_dot2_f32_bf16 v92, v26, v78, v92
    v_dot2_f32_bf16 v84, v27, v75, v84
    v_dot2_f32_bf16 v92, v27, v79, v92
    v_dot2_f32_bf16 v85, v28, v72, 0
    v_dot2_f32_bf16 v93, v28, v76, 0
    v_dot2_f32_bf16 v85, v29, v73, v85
    v_dot2_f32_bf16 v93, v29, v77, v93
    v_dot2_f32_bf16 v85, v30, v74, v85
    v_dot2_f32_bf16 v93, v30, v78, v93
    v_dot2_f32_bf16 v85, v31, v75, v85
    v_dot2_f32_bf16 v93, v31, v79, v93
    v_dot2_f32_bf16 v86, v32, v72, 0
    v_dot2_f32_bf16 v94, v32, v76, 0
    v_dot2_f32_bf16 v86, v33, v73, v86
    v_dot2_f32_bf16 v94, v33, v77, v94
    v_dot2_f32_bf16 v86, v34, v74, v86
    v_dot2_f32_bf16 v94, v34, v78, v94
    v_dot2_f32_bf16 v86, v35, v75, v86
    v_dot2_f32_bf16 v94, v35, v79, v94
    v_dot2_f32_bf16 v87, v36, v72, 0
    v_dot2_f32_bf16 v95, v36, v76, 0
    v_dot2_f32_bf16 v87, v37, v73, v87
    v_dot2_f32_bf16 v95, v37, v77, v95
    v_dot2_f32_bf16 v87, v38, v74, v87
    v_dot2_f32_bf16 v95, v38, v78, v95
    v_dot2_f32_bf16 v87, v39, v75, v87
    v_dot2_f32_bf16 v95, v39, v79, v95
    s_nop 3
    v_add_f32_dpp v80, v80, v80 row_ror:8 row_mask:0xf bank_mask:0xf
    v_add_f32_dpp v80, v88, v88 row_ror:8 row_mask:0xf bank_mask:0xc
    v_add_f32_dpp v81, v81, v81 row_ror:8 row_mask:0xf bank_mask:0xf
    v_add_f32_dpp v81, v89, v89 row_ror:8 row_mask:0xf bank_mask:0xc
    v_add_f32_dpp v82, v82, v82 row_ror:8 row_mask:0xf bank_mask:0xf
    v_add_f32_dpp v82, v90, v90 row_ror:8 row_mask:0xf bank_mask:0xc
    v_add_f32_dpp v83, v83, v83 row_ror:8 row_mask:0xf bank_mask:0xf
    v_add_f32_dpp v83, v91, v91 row_ror:8 row_mask:0xf bank_mask:0xc
    v_add_f32_dpp v84, v84, v84 row_ror:8 row_mask:0xf bank_mask:0xf
    v_add_f32_dpp v84, v92, v92 row_ror:8 row_mask:0xf bank_mask:0xc
    v_add_f32_dpp v85, v85, v85 row_ror:8 row_mask:0xf bank_mask:0xf
    v_add_f32_dpp v85, v93, v93 row_ror:8 row_mask:0xf bank_mask:0xc
    v_add_f32_dpp v86, v86, v86 row_ror:8 row_mask:0xf bank_mask:0xf
    v_add_f32_dpp v86, v94, v94 row_ror:8 row_mask:0xf bank_mask:0xc
    v_add_f32_dpp v87, v87, v87 row_ror:8 row_mask:0xf bank_mask:0xf
    v_add_f32_dpp v87, v95, v95 row_ror:8 row_mask:0xf bank_mask:0xc
    v_add_f32_dpp v80, v80, v80 row_half_mirror row_mask:0xf bank_mask:0xf
    v_add_f32_dpp v80, v84, v84 row_half_mirror row_mask:0xf bank_mask:0xa
    v_add_f32_dpp v81, v81, v81 row_half_mirror row_mask:0xf bank_mask:0xf
    v_add_f32_dpp v81, v85, v85 row_half_mirror row_mask:0xf bank_mask:0xa
    v_add_f32_dpp v82, v82, v82 row_half_mirror row_mask:0xf bank_mask:0xf
    v_add_f32_dpp v82, v86, v86 row_half_mirror row_mask:0xf bank_mask:0xa
    v_add_f32_dpp v83, v83, v83 row_half_mirror row_mask:0xf bank_mask:0xf
    v_add_f32_dpp v83, v87, v87 row_half_mirror row_mask:0xf bank_mask:0xa
    s_mov_b32 s12, 0xcccccccc
    s_mov_b32 s13, 0xcccccccc
    s_mov_b32 s10, 0xaaaaaaaa
    s_mov_b32 s11, 0xaaaaaaaa
    v_add_f32_dpp v88, v80, v80 quad_perm:[2,3,0,1] row_mask:0xf bank_mask:0xf
    v_add_f32_dpp v89, v82, v82 quad_perm:[2,3,0,1] row_mask:0xf bank_mask:0xf
    v_add_f32_dpp v90, v81, v81 quad_perm:[2,3,0,1] row_mask:0xf bank_mask:0xf
    v_add_f32_dpp v91, v83, v83 quad_perm:[2,3,0,1] row_mask:0xf bank_mask:0xf
    v_cndmask_b32 v80, v88, v89, s[12:13]
    v_cndmask_b32 v81, v90, v91, s[12:13]
    s_nop 1
    v_add_f32_dpp v88, v80, v80 quad_perm:[1,0,3,2] row_mask:0xf bank_mask:0xf
    v_add_f32_dpp v89, v81, v81 quad_perm:[1,0,3,2] row_mask:0xf bank_mask:0xf
    v_cndmask_b32 v80, v88, v89, s[10:11]
    v_cvt_pk_bf16_f32 v80, v80, v80
    v_lshlrev_b32 v80, 16, v80
    s_mov_b32 s10, 0x3db504f3
    v_mul_f32 v80, s10, v80
    v_cvt_pk_bf16_f32 v80, v80, v80
    v_lshlrev_b32 v80, 16, v80
    v_mov_b32 v4, v80
    s_nop 1
    v_max_f32_dpp v4, v4, v4 quad_perm:[1,0,3,2] row_mask:0xf bank_mask:0xf
    s_nop 1
    v_max_f32_dpp v4, v4, v4 quad_perm:[2,3,0,1] row_mask:0xf bank_mask:0xf
    s_nop 1
    v_max_f32_dpp v4, v4, v4 row_half_mirror row_mask:0xf bank_mask:0xf
    v_mov_b32 v5, v4
    s_nop 1
    v_permlane16_swap_b32 v4, v5
    v_max_f32 v4, v4, v5
    v_mov_b32 v5, v4
    s_nop 1
    v_permlane32_swap_b32 v4, v5
    v_max_f32 v4, v4, v5
    v_and_b32 v6, 8, v0
    v_lshlrev_b32 v6, 2, v6
    s_lshl_b32 s11, s15, 2
    v_add_u32 v3, s11, v6
    s_mov_b32 exec_lo, 0x101
    s_mov_b32 exec_hi, 0x0
    ds_write_b32 v3, v4 offset:5888
    s_mov_b64 exec, -1
    s_waitcnt lgkmcnt(0)
    v_mov_b32 v3, 8
    v_mov_b32 v5, 1
    s_mov_b64 exec, 1
    ds_add_u32 v3, v5
    s_mov_b64 exec, -1
    s_mov_b32 s79, 0x40000
L_cw_42:
    v_mov_b32 v3, 8
    ds_read_b32 v3, v3
    s_waitcnt lgkmcnt(0)
    v_readfirstlane_b32 s78, v3
    s_cmp_ge_u32 s78, 8
    s_cbranch_scc1 L_cwd_43

    s_sub_u32 s79, s79, 1
    s_cmp_lg_u32 s79, 0
    s_cbranch_scc1 L_cw_42
L_cwd_43:
    ds_read_b128 v[112:115], v6 offset:5888
    ds_read_b128 v[116:119], v6 offset:5904
    s_waitcnt lgkmcnt(0)
    v_max3_f32 v4, v112, v113, v114
    v_max3_f32 v4, v4, v115, v116
    v_max3_f32 v4, v4, v117, v118
    v_max_f32 v4, v4, v119
    s_mov_b32 s10, 0x3fb8aa3b
    v_sub_f32 v80, v80, v4
    v_mul_f32 v80, s10, v80
    v_exp_f32 v80, v80
    s_nop 0
    v_mov_b32 v4, v80
    s_nop 1
    v_add_f32_dpp v4, v4, v4 quad_perm:[1,0,3,2] row_mask:0xf bank_mask:0xf
    s_nop 1
    v_add_f32_dpp v4, v4, v4 quad_perm:[2,3,0,1] row_mask:0xf bank_mask:0xf
    s_nop 1
    v_add_f32_dpp v4, v4, v4 row_half_mirror row_mask:0xf bank_mask:0xf
    v_mov_b32 v5, v4
    s_nop 1
    v_permlane16_swap_b32 v4, v5
    v_add_f32 v4, v4, v5
    v_mov_b32 v5, v4
    s_nop 1
    v_permlane32_swap_b32 v4, v5
    v_add_f32 v4, v4, v5
    v_add_u32 v3, s11, v6
    s_mov_b32 exec_lo, 0x101
    s_mov_b32 exec_hi, 0x0
    ds_write_b32 v3, v4 offset:5952
    s_mov_b64 exec, -1
    s_waitcnt lgkmcnt(0)
    v_mov_b32 v3, 32
    v_mov_b32 v5, 1
    s_mov_b64 exec, 1
    ds_add_u32 v3, v5
    s_mov_b64 exec, -1
    v_cvt_pk_bf16_f32 v80, v80, v80
    v_and_b32 v4, 7, v0
    v_lshrrev_b32 v5, 1, v4
    v_and_b32 v4, 1, v4
    v_mov_b32 v6, 0xffff
    v_mov_b32 v7, 0xffff0000
    v_cmp_eq_u32 vcc, 1, v4
    s_nop 1
    v_cndmask_b32 v6, v6, v7, vcc
    v_cmp_eq_u32 vcc, 0, v5
    s_nop 1
    v_cndmask_b32 v112, 0, v6, vcc
    v_cmp_eq_u32 vcc, 1, v5
    s_nop 1
    v_cndmask_b32 v113, 0, v6, vcc
    v_cmp_eq_u32 vcc, 2, v5
    s_nop 1
    v_cndmask_b32 v114, 0, v6, vcc
    v_cmp_eq_u32 vcc, 3, v5
    s_nop 1
    v_cndmask_b32 v115, 0, v6, vcc
    v_mov_b32_dpp v116, v80 row_newbcast:0 row_mask:0xf bank_mask:0x3
    v_mov_b32_dpp v116, v80 row_newbcast:8 row_mask:0xf bank_mask:0xc
    v_and_b32 v8, v116, v112
    v_and_b32 v9, v116, v113
    v_and_b32 v10, v116, v114
    v_and_b32 v11, v116, v115
    v_mov_b32_dpp v117, v80 row_newbcast:1 row_mask:0xf bank_mask:0x3
    v_mov_b32_dpp v117, v80 row_newbcast:9 row_mask:0xf bank_mask:0xc
    v_and_b32 v12, v117, v112
    v_and_b32 v13, v117, v113
    v_and_b32 v14, v117, v114
    v_and_b32 v15, v117, v115
    v_mov_b32_dpp v116, v80 row_newbcast:2 row_mask:0xf bank_mask:0x3
    v_mov_b32_dpp v116, v80 row_newbcast:10 row_mask:0xf bank_mask:0xc
    v_and_b32 v16, v116, v112
    v_and_b32 v17, v116, v113
    v_and_b32 v18, v116, v114
    v_and_b32 v19, v116, v115
    v_mov_b32_dpp v117, v80 row_newbcast:3 row_mask:0xf bank_mask:0x3
    v_mov_b32_dpp v117, v80 row_newbcast:11 row_mask:0xf bank_mask:0xc
    v_and_b32 v20, v117, v112
    v_and_b32 v21, v117, v113
    v_and_b32 v22, v117, v114
    v_and_b32 v23, v117, v115
    v_mov_b32_dpp v116, v80 row_newbcast:4 row_mask:0xf bank_mask:0x3
    v_mov_b32_dpp v116, v80 row_newbcast:12 row_mask:0xf bank_mask:0xc
    v_and_b32 v24, v116, v112
    v_and_b32 v25, v116, v113
    v_and_b32 v26, v116, v114
    v_and_b32 v27, v116, v115
    v_mov_b32_dpp v117, v80 row_newbcast:5 row_mask:0xf bank_mask:0x3
    v_mov_b32_dpp v117, v80 row_newbcast:13 row_mask:0xf bank_mask:0xc
    v_and_b32 v28, v117, v112
    v_and_b32 v29, v117, v113
    v_and_b32 v30, v117, v114
    v_and_b32 v31, v117, v115
    v_mov_b32_dpp v116, v80 row_newbcast:6 row_mask:0xf bank_mask:0x3
    v_mov_b32_dpp v116, v80 row_newbcast:14 row_mask:0xf bank_mask:0xc
    v_and_b32 v32, v116, v112
    v_and_b32 v33, v116, v113
    v_and_b32 v34, v116, v114
    v_and_b32 v35, v116, v115
    v_mov_b32_dpp v117, v80 row_newbcast:7 row_mask:0xf bank_mask:0x3
    v_mov_b32_dpp v117, v80 row_newbcast:15 row_mask:0xf bank_mask:0xc
    v_and_b32 v36, v117, v112
    v_and_b32 v37, v117, v113
    v_and_b32 v38, v117, v114
    v_and_b32 v39, v117, v115
    s_mov_b32 s77, 1
    s_setpc_b64 s[74:75]
L_end:
    s_endpgm
.section .rodata,"a"
.p2align 6
.amdhsa_kernel parallel_sum__sliding_block_cached__mixer_channel_mlp__decode_kernel
  .amdhsa_next_free_vgpr 128
  .amdhsa_next_free_sgpr 102
  .amdhsa_accum_offset 128
  .amdhsa_group_segment_fixed_size 0
  .amdhsa_kernarg_size 104
  .amdhsa_user_sgpr_count 2
  .amdhsa_user_sgpr_kernarg_segment_ptr 1
  .amdhsa_system_sgpr_workgroup_id_x 1
.end_amdhsa_kernel
```
